```python
import torch

def _softmax(x, axis=-1):
    return torch.softmax(x, dim=axis)
def _gelu(x):
    return torch.nn.functional.gelu(x, approximate="tanh")
def _silu(x):
    return torch.nn.functional.silu(x)
def _sigmoid(x):
    return torch.sigmoid(x)
def _layernorm(x, axis=-1, eps=1e-5):
    m = x.mean(dim=axis, keepdim=True)
    v = x.var(dim=axis, keepdim=True, unbiased=False)
    return (x - m) / torch.sqrt(v + eps)
def _scatter_add(tgt, idx, src, axis=0):
    return tgt.clone().index_add_(axis, idx, src)
def _segment_sum(src, seg, n):
    out = torch.zeros((n,) + src.shape[1:], dtype=src.dtype)
    return out.index_add_(0, seg, src)
def _pad(x, pw):
    flat = tuple(v for pair in reversed(pw) for v in pair)
    return torch.nn.functional.pad(x, flat)

kernel_name = 'standalone__kv_cache_quant_int4_int2_kv_with_per_channel_or_per_token_scales__decode'

def setup_inputs():

    _w = (lambda a: (lambda t: t.to(torch.bfloat16) if t.is_floating_point() else t)(torch.as_tensor(a)))
    B = 2
    Sq = 1
    Skv = 32768
    Hq = 32
    Hkv = 4
    Dh = 128
    bits = 3
    G = 128
    if G <= 0 or G >= Skv:
        G = max(1, Skv // 2)
    Skv = (Skv // G) * G
    ngk = Skv // G
    qmax = (1 << bits) - 1
    return {
        "q": _w((lambda *s: torch.randn(*s, dtype=torch.bfloat16) * 1.6)(B, Hq, Sq, Dh)),
        "qk": _w(torch.randint(0, qmax + 1, (B, Hkv, Skv, Dh)).to(torch.int32)),
        "qv": _w(torch.randint(0, qmax + 1, (B, Hkv, Skv, Dh)).to(torch.int32)),
        "k_scales": _w(torch.abs((lambda *s: torch.randn(*s, dtype=torch.bfloat16) * 1.6)(B, Hkv, ngk, Dh)) * 0.05 + 0.02),
        "k_zeros": _w((lambda *s: torch.randn(*s, dtype=torch.bfloat16) * 1.6)(B, Hkv, ngk, Dh) + float(qmax) / 2.0),
        "v_scales": _w(torch.abs((lambda *s: torch.randn(*s, dtype=torch.bfloat16) * 0.05)(B, Hkv, Skv, 1)) * 0.05 + 0.02),
        "v_zeros": _w((lambda *s: torch.randn(*s, dtype=torch.bfloat16) * 0.05)(B, Hkv, Skv, 1) + float(qmax) / 2.0),
    }

def reference(q, qk, qv, k_scales, k_zeros, v_scales, v_zeros):
    B, Hq, Sq, Dh = q.shape
    Hkv, Skv = qk.shape[1], qk.shape[2]
    ngk = k_scales.shape[2]
    G = Skv // ngk
    ks = (lambda x, n, axis: torch.repeat_interleave(x, n, dim=axis))(k_scales, G, axis=2)
    kz = (lambda x, n, axis: torch.repeat_interleave(x, n, dim=axis))(k_zeros, G, axis=2)
    k = ((lambda x, dt: x.to(dt))(qk, q.dtype) - kz) * ks
    v = ((lambda x, dt: x.to(dt))(qv, q.dtype) - v_zeros) * v_scales
    rep = Hq // Hkv
    if rep > 1:
        k = (lambda x, n, axis: torch.repeat_interleave(x, n, dim=axis))(k, rep, axis=1)
        v = (lambda x, n, axis: torch.repeat_interleave(x, n, dim=axis))(v, rep, axis=1)
    scale = float(Dh) ** -0.5
    logits = torch.einsum("bhqd,bhkd->bhqk", q, k) * scale
    p = _softmax(logits, axis=-1)
    o = torch.einsum("bhqk,bhkd->bhqd", p, v)
    return o
```

```asm
; @launch grid=(256,1,1) block=(256,1,1) lds=28944
.amdgcn_target "amdgcn-amd-amdhsa--gfx950"
.text
.globl standalone__kv_cache_quant_int4_int2_kv_with_per_channel_or_per_token_scales__decode_kernel
.p2align 8
.type standalone__kv_cache_quant_int4_int2_kv_with_per_channel_or_per_token_scales__decode_kernel,@function
standalone__kv_cache_quant_int4_int2_kv_with_per_channel_or_per_token_scales__decode_kernel:
    s_cmp_ge_u32 s2, 256
    s_cbranch_scc1 L_main_end
    v_lshrrev_b32 v1, 6, v0
    s_load_dwordx2 s[36:37], s[0:1], 8
    v_readfirstlane_b32 s3, v1
    s_load_dwordx2 s[44:45], s[0:1], 0
    s_load_dwordx2 s[56:57], s[0:1], 64
    v_and_b32 v2, 63, v0
    s_lshl_b32 s65, s3, 3
    s_add_u32 s65, s65, 24
    s_load_dwordx2 s[48:49], s[0:1], s65
    s_memrealtime s[70:71]
    v_lshlrev_b32 v128, 4, v2
    v_add_u32 v129, 0x1000, v128
    s_mov_b32 s38, 0x8000000
    s_mov_b32 s39, 0x20000
    s_mov_b32 s50, 0x80000
    s_mov_b32 s51, 0x20000
    s_mov_b32 s46, 0x4000
    s_mov_b32 s47, 0x20000
    s_mov_b32 s58, 0x100
    s_mov_b32 s59, 0x20000
    s_lshr_b32 s15, s2, 5
    s_and_b32 s67, s2, 31
    s_lshl_b32 s4, s15, 24
    s_lshl_b32 s65, s67, 17
    s_or_b32 s4, s4, s65
    s_lshr_b32 s66, s4, 8
    s_lshl_b32 s65, s3, 13
    s_or_b32 s4, s4, s65
    v_and_b32 v3, 31, v2
    v_lshrrev_b32 v7, 5, v2
    v_lshlrev_b32 v6, 14, v7
    v_lshl_add_u32 v100, v3, 4, v6
    v_mov_b32 v137, 0
    v_mov_b32 v138, 0
    s_lshl_b32 s64, s3, 11
    s_add_u32 m0, s64, 18432
    s_waitcnt lgkmcnt(0)
    s_lshl_b32 s64, s15, 5
    s_cmp_lg_u32 s3, 3
    s_cbranch_scc1 L_no_nonce
    s_or_b32 s70, s70, 1
    v_mov_b32 v136, s70
    s_mov_b64 exec, 1
    buffer_atomic_cmpswap v[136:137], v138, s[56:59], s64 offen sc0
    s_mov_b64 exec, -1
L_no_nonce:
    buffer_load_dwordx4 v[160:163], v128, s[36:39], s4 offen offset:0 nt
    buffer_load_dwordx4 v[164:167], v128, s[36:39], s4 offen offset:1024 nt
    buffer_load_dwordx4 v[168:171], v128, s[36:39], s4 offen offset:2048 nt
    buffer_load_dwordx4 v[172:175], v128, s[36:39], s4 offen offset:3072 nt
    buffer_load_dwordx4 v[176:179], v129, s[36:39], s4 offen offset:0 nt
    buffer_load_dwordx4 v[180:183], v129, s[36:39], s4 offen offset:1024 nt
    buffer_load_dwordx4 v[184:187], v129, s[36:39], s4 offen offset:2048 nt
    buffer_load_dwordx4 v[188:191], v129, s[36:39], s4 offen offset:3072 nt
    buffer_load_dwordx4 v100, s[48:51], s66 offen lds
    s_add_u32 m0, m0, 1024
    s_add_u32 s66, s66, 0x8000
    buffer_load_dwordx4 v100, s[48:51], s66 offen lds
    s_lshl_b32 s65, s3, 9
    s_add_u32 m0, s65, 26624
    s_lshl_b32 s66, s15, 11
    s_add_u32 s66, s66, s65
    s_mov_b32 exec_hi, 0
    buffer_load_dwordx4 v128, s[44:47], s66 offen lds
    s_mov_b32 exec_hi, -1
    s_add_u32 s6, s4, 0x8000
    buffer_load_dwordx4 v[192:195], v128, s[36:39], s6 offen offset:0 nt
    buffer_load_dwordx4 v[196:199], v128, s[36:39], s6 offen offset:1024 nt
    buffer_load_dwordx4 v[200:203], v128, s[36:39], s6 offen offset:2048 nt
    buffer_load_dwordx4 v[204:207], v128, s[36:39], s6 offen offset:3072 nt
    buffer_load_dwordx4 v[208:211], v129, s[36:39], s6 offen offset:0 nt
    buffer_load_dwordx4 v[212:215], v129, s[36:39], s6 offen offset:1024 nt
    buffer_load_dwordx4 v[216:219], v129, s[36:39], s6 offen offset:2048 nt
    buffer_load_dwordx4 v[220:223], v129, s[36:39], s6 offen offset:3072 nt
    s_load_dwordx2 s[40:41], s[0:1], 16
    s_load_dwordx2 s[52:53], s[0:1], 72
    s_load_dwordx2 s[60:61], s[0:1], 56
    v_lshrrev_b32 v4, 4, v2
    v_and_b32 v5, 15, v2
    v_lshlrev_b32 v6, 4, v5
    v_lshl_add_u32 v130, v4, 11, v6
    v_lshlrev_b32 v134, 3, v3
    s_lshl_b32 s64, s3, 5
    v_lshlrev_b32 v6, 3, v4
    v_add_u32 v135, s64, v6
    v_and_b32 v9, 7, v2
    v_lshlrev_b32 v6, 8, v9
    v_lshl_add_u32 v101, v4, 4, v6
    s_mul_i32 s64, s3, 4608
    v_mul_u32_u24 v6, 288, v7
    v_add3_u32 v131, v6, v134, s64
    v_mul_u32_u24 v6, 288, v5
    v_lshl_add_u32 v6, v4, 4, v6
    v_add_u32 v132, s64, v6
    v_lshrrev_b32 v6, 3, v5
    v_sub_u32 v6, 0, v6
    v_lshlrev_b32 v133, 16, v6
    s_mov_b32 s42, 0x8000000
    s_mov_b32 s43, 0x20000
    s_mov_b32 s54, 0x20000000
    s_mov_b32 s55, 0x20000
    s_mov_b32 s62, 0x4000
    s_mov_b32 s63, 0x20000
    s_mov_b32 s12, 0x07060302
    s_mov_b32 s13, 0x3e0293ee
    s_mov_b32 s14, 0xffff0000
    s_waitcnt vmcnt(8)
    s_barrier
    ds_read_b128 v[0:3], v101 offset:26624
    ds_read_b128 v[4:7], v101 offset:26688
    ds_read_b128 v[8:11], v101 offset:26752
    ds_read_b128 v[12:15], v101 offset:26816
    ds_read_b64 v[124:125], v134 offset:18432
    ds_read_b64 v[126:127], v134 offset:20480
    s_add_u32 s5, s4, 0x10000
    s_waitcnt vmcnt(1)
    buffer_load_dwordx4 v[224:227], v128, s[36:39], s5 offen offset:0 nt
    buffer_load_dwordx4 v[228:231], v128, s[36:39], s5 offen offset:1024 nt
    buffer_load_dwordx4 v[232:235], v128, s[36:39], s5 offen offset:2048 nt
    buffer_load_dwordx4 v[236:239], v128, s[36:39], s5 offen offset:3072 nt
    buffer_load_dwordx4 v[240:243], v129, s[36:39], s5 offen offset:0 nt
    buffer_load_dwordx4 v[244:247], v129, s[36:39], s5 offen offset:1024 nt
    buffer_load_dwordx4 v[248:251], v129, s[36:39], s5 offen offset:2048 nt
    buffer_load_dwordx4 v[252:255], v129, s[36:39], s5 offen offset:3072 nt
    s_waitcnt lgkmcnt(0)
    v_lshlrev_b32 v116, 16, v124
    v_and_b32 v117, s14, v124
    v_lshlrev_b32 v118, 16, v125
    v_and_b32 v119, s14, v125
    v_lshlrev_b32 v120, 16, v126
    v_and_b32 v121, s14, v126
    v_lshlrev_b32 v122, 16, v127
    v_and_b32 v123, s14, v127
    v_mul_f32 v120, -v120, v116
    v_mul_f32 v121, -v121, v117
    v_mul_f32 v122, -v122, v118
    v_mul_f32 v123, -v123, v119
    v_cvt_f32_i32 v160, v160
    v_cvt_f32_i32 v161, v161
    v_cvt_f32_i32 v162, v162
    v_cvt_f32_i32 v163, v163
    v_pk_fma_f32 v[160:161], v[160:161], v[116:117], v[120:121]
    v_pk_fma_f32 v[162:163], v[162:163], v[118:119], v[122:123]
    v_cvt_pk_bf16_f32 v160, v160, v161
    v_cvt_pk_bf16_f32 v161, v162, v163
    ds_write_b64 v131, v[160:161] offset:0
    v_cvt_f32_i32 v164, v164
    v_cvt_f32_i32 v165, v165
    v_cvt_f32_i32 v166, v166
    v_cvt_f32_i32 v167, v167
    v_pk_fma_f32 v[164:165], v[164:165], v[116:117], v[120:121]
    v_pk_fma_f32 v[166:167], v[166:167], v[118:119], v[122:123]
    v_cvt_pk_bf16_f32 v164, v164, v165
    v_cvt_pk_bf16_f32 v165, v166, v167
    ds_write_b64 v131, v[164:165] offset:576
    v_cvt_f32_i32 v168, v168
    v_cvt_f32_i32 v169, v169
    v_cvt_f32_i32 v170, v170
    v_cvt_f32_i32 v171, v171
    v_pk_fma_f32 v[168:169], v[168:169], v[116:117], v[120:121]
    v_pk_fma_f32 v[170:171], v[170:171], v[118:119], v[122:123]
    v_cvt_pk_bf16_f32 v168, v168, v169
    v_cvt_pk_bf16_f32 v169, v170, v171
    ds_write_b64 v131, v[168:169] offset:1152
    v_cvt_f32_i32 v172, v172
    v_cvt_f32_i32 v173, v173
    v_cvt_f32_i32 v174, v174
    v_cvt_f32_i32 v175, v175
    v_pk_fma_f32 v[172:173], v[172:173], v[116:117], v[120:121]
    v_pk_fma_f32 v[174:175], v[174:175], v[118:119], v[122:123]
    v_cvt_pk_bf16_f32 v172, v172, v173
    v_cvt_pk_bf16_f32 v173, v174, v175
    ds_write_b64 v131, v[172:173] offset:1728
    v_cvt_f32_i32 v176, v176
    v_cvt_f32_i32 v177, v177
    v_cvt_f32_i32 v178, v178
    v_cvt_f32_i32 v179, v179
    v_pk_fma_f32 v[176:177], v[176:177], v[116:117], v[120:121]
    v_pk_fma_f32 v[178:179], v[178:179], v[118:119], v[122:123]
    v_cvt_pk_bf16_f32 v176, v176, v177
    v_cvt_pk_bf16_f32 v177, v178, v179
    ds_write_b64 v131, v[176:177] offset:2304
    v_cvt_f32_i32 v180, v180
    v_cvt_f32_i32 v181, v181
    v_cvt_f32_i32 v182, v182
    v_cvt_f32_i32 v183, v183
    v_pk_fma_f32 v[180:181], v[180:181], v[116:117], v[120:121]
    v_pk_fma_f32 v[182:183], v[182:183], v[118:119], v[122:123]
    v_cvt_pk_bf16_f32 v180, v180, v181
    v_cvt_pk_bf16_f32 v181, v182, v183
    ds_write_b64 v131, v[180:181] offset:2880
    v_cvt_f32_i32 v184, v184
    v_cvt_f32_i32 v185, v185
    v_cvt_f32_i32 v186, v186
    v_cvt_f32_i32 v187, v187
    v_pk_fma_f32 v[184:185], v[184:185], v[116:117], v[120:121]
    v_pk_fma_f32 v[186:187], v[186:187], v[118:119], v[122:123]
    v_cvt_pk_bf16_f32 v184, v184, v185
    v_cvt_pk_bf16_f32 v185, v186, v187
    ds_write_b64 v131, v[184:185] offset:3456
    v_cvt_f32_i32 v188, v188
    v_cvt_f32_i32 v189, v189
    v_cvt_f32_i32 v190, v190
    v_cvt_f32_i32 v191, v191
    v_pk_fma_f32 v[188:189], v[188:189], v[116:117], v[120:121]
    v_pk_fma_f32 v[190:191], v[190:191], v[118:119], v[122:123]
    v_cvt_pk_bf16_f32 v188, v188, v189
    v_cvt_pk_bf16_f32 v189, v190, v191
    ds_write_b64 v131, v[188:189] offset:4032
    ds_read_b128 v[100:103], v132 offset:0
    ds_read_b128 v[104:107], v132 offset:64
    ds_read_b128 v[108:111], v132 offset:128
    ds_read_b128 v[112:115], v132 offset:192
    s_add_u32 s6, s4, 0x18000
    s_waitcnt vmcnt(1)
    buffer_load_dwordx4 v[160:163], v128, s[36:39], s6 offen offset:0 nt
    buffer_load_dwordx4 v[164:167], v128, s[36:39], s6 offen offset:1024 nt
    buffer_load_dwordx4 v[168:171], v128, s[36:39], s6 offen offset:2048 nt
    buffer_load_dwordx4 v[172:175], v128, s[36:39], s6 offen offset:3072 nt
    buffer_load_dwordx4 v[176:179], v129, s[36:39], s6 offen offset:0 nt
    buffer_load_dwordx4 v[180:183], v129, s[36:39], s6 offen offset:1024 nt
    buffer_load_dwordx4 v[184:187], v129, s[36:39], s6 offen offset:2048 nt
    buffer_load_dwordx4 v[188:191], v129, s[36:39], s6 offen offset:3072 nt
    s_waitcnt lgkmcnt(3)
    v_mfma_f32_16x16x32_bf16 v[32:35], v[100:103], v[0:3], 0
    s_waitcnt lgkmcnt(2)
    v_mfma_f32_16x16x32_bf16 v[32:35], v[104:107], v[4:7], v[32:35]
    s_waitcnt lgkmcnt(1)
    v_mfma_f32_16x16x32_bf16 v[32:35], v[108:111], v[8:11], v[32:35]
    s_waitcnt lgkmcnt(0)
    v_mfma_f32_16x16x32_bf16 v[32:35], v[112:115], v[12:15], v[32:35]
    s_waitcnt vmcnt(20)
    v_cvt_f32_i32 v192, v192
    v_cvt_f32_i32 v193, v193
    v_cvt_f32_i32 v194, v194
    v_cvt_f32_i32 v195, v195
    v_pk_fma_f32 v[192:193], v[192:193], v[116:117], v[120:121]
    v_pk_fma_f32 v[194:195], v[194:195], v[118:119], v[122:123]
    v_cvt_pk_bf16_f32 v192, v192, v193
    v_cvt_pk_bf16_f32 v193, v194, v195
    ds_write_b64 v131, v[192:193] offset:0
    v_cvt_f32_i32 v196, v196
    v_cvt_f32_i32 v197, v197
    v_cvt_f32_i32 v198, v198
    v_cvt_f32_i32 v199, v199
    v_pk_fma_f32 v[196:197], v[196:197], v[116:117], v[120:121]
    v_pk_fma_f32 v[198:199], v[198:199], v[118:119], v[122:123]
    v_cvt_pk_bf16_f32 v196, v196, v197
    v_cvt_pk_bf16_f32 v197, v198, v199
    ds_write_b64 v131, v[196:197] offset:576
    v_cvt_f32_i32 v200, v200
    v_cvt_f32_i32 v201, v201
    v_cvt_f32_i32 v202, v202
    v_cvt_f32_i32 v203, v203
    v_pk_fma_f32 v[200:201], v[200:201], v[116:117], v[120:121]
    v_pk_fma_f32 v[202:203], v[202:203], v[118:119], v[122:123]
    v_cvt_pk_bf16_f32 v200, v200, v201
    v_cvt_pk_bf16_f32 v201, v202, v203
    ds_write_b64 v131, v[200:201] offset:1152
    v_cvt_f32_i32 v204, v204
    v_cvt_f32_i32 v205, v205
    v_cvt_f32_i32 v206, v206
    v_cvt_f32_i32 v207, v207
    v_pk_fma_f32 v[204:205], v[204:205], v[116:117], v[120:121]
    v_pk_fma_f32 v[206:207], v[206:207], v[118:119], v[122:123]
    v_cvt_pk_bf16_f32 v204, v204, v205
    v_cvt_pk_bf16_f32 v205, v206, v207
    ds_write_b64 v131, v[204:205] offset:1728
    s_waitcnt vmcnt(16)
    v_cvt_f32_i32 v208, v208
    v_cvt_f32_i32 v209, v209
    v_cvt_f32_i32 v210, v210
    v_cvt_f32_i32 v211, v211
    v_pk_fma_f32 v[208:209], v[208:209], v[116:117], v[120:121]
    v_pk_fma_f32 v[210:211], v[210:211], v[118:119], v[122:123]
    v_cvt_pk_bf16_f32 v208, v208, v209
    v_cvt_pk_bf16_f32 v209, v210, v211
    ds_write_b64 v131, v[208:209] offset:2304
    v_cvt_f32_i32 v212, v212
    v_cvt_f32_i32 v213, v213
    v_cvt_f32_i32 v214, v214
    v_cvt_f32_i32 v215, v215
    v_pk_fma_f32 v[212:213], v[212:213], v[116:117], v[120:121]
    v_pk_fma_f32 v[214:215], v[214:215], v[118:119], v[122:123]
    v_cvt_pk_bf16_f32 v212, v212, v213
    v_cvt_pk_bf16_f32 v213, v214, v215
    ds_write_b64 v131, v[212:213] offset:2880
    v_cvt_f32_i32 v216, v216
    v_cvt_f32_i32 v217, v217
    v_cvt_f32_i32 v218, v218
    v_cvt_f32_i32 v219, v219
    v_pk_fma_f32 v[216:217], v[216:217], v[116:117], v[120:121]
    v_pk_fma_f32 v[218:219], v[218:219], v[118:119], v[122:123]
    v_cvt_pk_bf16_f32 v216, v216, v217
    v_cvt_pk_bf16_f32 v217, v218, v219
    ds_write_b64 v131, v[216:217] offset:3456
    v_cvt_f32_i32 v220, v220
    v_cvt_f32_i32 v221, v221
    v_cvt_f32_i32 v222, v222
    v_cvt_f32_i32 v223, v223
    v_pk_fma_f32 v[220:221], v[220:221], v[116:117], v[120:121]
    v_pk_fma_f32 v[222:223], v[222:223], v[118:119], v[122:123]
    v_cvt_pk_bf16_f32 v220, v220, v221
    v_cvt_pk_bf16_f32 v221, v222, v223
    ds_write_b64 v131, v[220:221] offset:4032
    ds_read_b128 v[100:103], v132 offset:0
    ds_read_b128 v[104:107], v132 offset:64
    ds_read_b128 v[108:111], v132 offset:128
    ds_read_b128 v[112:115], v132 offset:192
    ds_read_b64 v[124:125], v134 offset:18688
    ds_read_b64 v[126:127], v134 offset:20736
    s_add_u32 s5, s4, 0x400000
    s_waitcnt vmcnt(1)
    buffer_load_dwordx4 v[192:195], v128, s[36:39], s5 offen offset:0 nt
    buffer_load_dwordx4 v[196:199], v128, s[36:39], s5 offen offset:1024 nt
    buffer_load_dwordx4 v[200:203], v128, s[36:39], s5 offen offset:2048 nt
    buffer_load_dwordx4 v[204:207], v128, s[36:39], s5 offen offset:3072 nt
    buffer_load_dwordx4 v[208:211], v129, s[36:39], s5 offen offset:0 nt
    buffer_load_dwordx4 v[212:215], v129, s[36:39], s5 offen offset:1024 nt
    buffer_load_dwordx4 v[216:219], v129, s[36:39], s5 offen offset:2048 nt
    buffer_load_dwordx4 v[220:223], v129, s[36:39], s5 offen offset:3072 nt
    s_waitcnt lgkmcnt(5)
    v_mfma_f32_16x16x32_bf16 v[36:39], v[100:103], v[0:3], 0
    s_waitcnt lgkmcnt(4)
    v_mfma_f32_16x16x32_bf16 v[36:39], v[104:107], v[4:7], v[36:39]
    s_waitcnt lgkmcnt(3)
    v_mfma_f32_16x16x32_bf16 v[36:39], v[108:111], v[8:11], v[36:39]
    s_waitcnt lgkmcnt(2)
    v_mfma_f32_16x16x32_bf16 v[36:39], v[112:115], v[12:15], v[36:39]
    s_waitcnt lgkmcnt(0)
    v_lshlrev_b32 v116, 16, v124
    v_and_b32 v117, s14, v124
    v_lshlrev_b32 v118, 16, v125
    v_and_b32 v119, s14, v125
    v_lshlrev_b32 v120, 16, v126
    v_and_b32 v121, s14, v126
    v_lshlrev_b32 v122, 16, v127
    v_and_b32 v123, s14, v127
    v_mul_f32 v120, -v120, v116
    v_mul_f32 v121, -v121, v117
    v_mul_f32 v122, -v122, v118
    v_mul_f32 v123, -v123, v119
    v_max_f32 v156, v32, v33
    v_max_f32 v157, v34, v35
    s_waitcnt vmcnt(20)
    v_cvt_f32_i32 v224, v224
    v_cvt_f32_i32 v225, v225
    v_cvt_f32_i32 v226, v226
    v_cvt_f32_i32 v227, v227
    v_pk_fma_f32 v[224:225], v[224:225], v[116:117], v[120:121]
    v_pk_fma_f32 v[226:227], v[226:227], v[118:119], v[122:123]
    v_cvt_pk_bf16_f32 v224, v224, v225
    v_cvt_pk_bf16_f32 v225, v226, v227
    ds_write_b64 v131, v[224:225] offset:0
    v_cvt_f32_i32 v228, v228
    v_cvt_f32_i32 v229, v229
    v_cvt_f32_i32 v230, v230
    v_cvt_f32_i32 v231, v231
    v_pk_fma_f32 v[228:229], v[228:229], v[116:117], v[120:121]
    v_pk_fma_f32 v[230:231], v[230:231], v[118:119], v[122:123]
    v_cvt_pk_bf16_f32 v228, v228, v229
    v_cvt_pk_bf16_f32 v229, v230, v231
    ds_write_b64 v131, v[228:229] offset:576
    v_cvt_f32_i32 v232, v232
    v_cvt_f32_i32 v233, v233
    v_cvt_f32_i32 v234, v234
    v_cvt_f32_i32 v235, v235
    v_pk_fma_f32 v[232:233], v[232:233], v[116:117], v[120:121]
    v_pk_fma_f32 v[234:235], v[234:235], v[118:119], v[122:123]
    v_cvt_pk_bf16_f32 v232, v232, v233
    v_cvt_pk_bf16_f32 v233, v234, v235
    ds_write_b64 v131, v[232:233] offset:1152
    v_cvt_f32_i32 v236, v236
    v_cvt_f32_i32 v237, v237
    v_cvt_f32_i32 v238, v238
    v_cvt_f32_i32 v239, v239
    v_pk_fma_f32 v[236:237], v[236:237], v[116:117], v[120:121]
    v_pk_fma_f32 v[238:239], v[238:239], v[118:119], v[122:123]
    v_cvt_pk_bf16_f32 v236, v236, v237
    v_cvt_pk_bf16_f32 v237, v238, v239
    ds_write_b64 v131, v[236:237] offset:1728
    s_waitcnt vmcnt(16)
    v_cvt_f32_i32 v240, v240
    v_cvt_f32_i32 v241, v241
    v_cvt_f32_i32 v242, v242
    v_cvt_f32_i32 v243, v243
    v_pk_fma_f32 v[240:241], v[240:241], v[116:117], v[120:121]
    v_pk_fma_f32 v[242:243], v[242:243], v[118:119], v[122:123]
    v_cvt_pk_bf16_f32 v240, v240, v241
    v_cvt_pk_bf16_f32 v241, v242, v243
    ds_write_b64 v131, v[240:241] offset:2304
    v_cvt_f32_i32 v244, v244
    v_cvt_f32_i32 v245, v245
    v_cvt_f32_i32 v246, v246
    v_cvt_f32_i32 v247, v247
    v_pk_fma_f32 v[244:245], v[244:245], v[116:117], v[120:121]
    v_pk_fma_f32 v[246:247], v[246:247], v[118:119], v[122:123]
    v_cvt_pk_bf16_f32 v244, v244, v245
    v_cvt_pk_bf16_f32 v245, v246, v247
    ds_write_b64 v131, v[244:245] offset:2880
    v_cvt_f32_i32 v248, v248
    v_cvt_f32_i32 v249, v249
    v_cvt_f32_i32 v250, v250
    v_cvt_f32_i32 v251, v251
    v_pk_fma_f32 v[248:249], v[248:249], v[116:117], v[120:121]
    v_pk_fma_f32 v[250:251], v[250:251], v[118:119], v[122:123]
    v_cvt_pk_bf16_f32 v248, v248, v249
    v_cvt_pk_bf16_f32 v249, v250, v251
    ds_write_b64 v131, v[248:249] offset:3456
    v_cvt_f32_i32 v252, v252
    v_cvt_f32_i32 v253, v253
    v_cvt_f32_i32 v254, v254
    v_cvt_f32_i32 v255, v255
    v_pk_fma_f32 v[252:253], v[252:253], v[116:117], v[120:121]
    v_pk_fma_f32 v[254:255], v[254:255], v[118:119], v[122:123]
    v_cvt_pk_bf16_f32 v252, v252, v253
    v_cvt_pk_bf16_f32 v253, v254, v255
    ds_write_b64 v131, v[252:253] offset:4032
    ds_read_b128 v[100:103], v132 offset:0
    ds_read_b128 v[104:107], v132 offset:64
    ds_read_b128 v[108:111], v132 offset:128
    ds_read_b128 v[112:115], v132 offset:192
    s_add_u32 s6, s4, 0x408000
    s_waitcnt vmcnt(1)
    buffer_load_dwordx4 v[224:227], v128, s[36:39], s6 offen offset:0 nt
    buffer_load_dwordx4 v[228:231], v128, s[36:39], s6 offen offset:1024 nt
    buffer_load_dwordx4 v[232:235], v128, s[36:39], s6 offen offset:2048 nt
    buffer_load_dwordx4 v[236:239], v128, s[36:39], s6 offen offset:3072 nt
    buffer_load_dwordx4 v[240:243], v129, s[36:39], s6 offen offset:0 nt
    buffer_load_dwordx4 v[244:247], v129, s[36:39], s6 offen offset:1024 nt
    buffer_load_dwordx4 v[248:251], v129, s[36:39], s6 offen offset:2048 nt
    buffer_load_dwordx4 v[252:255], v129, s[36:39], s6 offen offset:3072 nt
    s_waitcnt lgkmcnt(3)
    v_mfma_f32_16x16x32_bf16 v[40:43], v[100:103], v[0:3], 0
    s_waitcnt lgkmcnt(2)
    v_mfma_f32_16x16x32_bf16 v[40:43], v[104:107], v[4:7], v[40:43]
    s_waitcnt lgkmcnt(1)
    v_mfma_f32_16x16x32_bf16 v[40:43], v[108:111], v[8:11], v[40:43]
    s_waitcnt lgkmcnt(0)
    v_mfma_f32_16x16x32_bf16 v[40:43], v[112:115], v[12:15], v[40:43]
    v_max3_f32 v156, v156, v36, v37
    v_max3_f32 v157, v157, v38, v39
    s_waitcnt vmcnt(20)
    v_cvt_f32_i32 v160, v160
    v_cvt_f32_i32 v161, v161
    v_cvt_f32_i32 v162, v162
    v_cvt_f32_i32 v163, v163
    v_pk_fma_f32 v[160:161], v[160:161], v[116:117], v[120:121]
    v_pk_fma_f32 v[162:163], v[162:163], v[118:119], v[122:123]
    v_cvt_pk_bf16_f32 v160, v160, v161
    v_cvt_pk_bf16_f32 v161, v162, v163
    ds_write_b64 v131, v[160:161] offset:0
    v_cvt_f32_i32 v164, v164
    v_cvt_f32_i32 v165, v165
    v_cvt_f32_i32 v166, v166
    v_cvt_f32_i32 v167, v167
    v_pk_fma_f32 v[164:165], v[164:165], v[116:117], v[120:121]
    v_pk_fma_f32 v[166:167], v[166:167], v[118:119], v[122:123]
    v_cvt_pk_bf16_f32 v164, v164, v165
    v_cvt_pk_bf16_f32 v165, v166, v167
    ds_write_b64 v131, v[164:165] offset:576
    v_cvt_f32_i32 v168, v168
    v_cvt_f32_i32 v169, v169
    v_cvt_f32_i32 v170, v170
    v_cvt_f32_i32 v171, v171
    v_pk_fma_f32 v[168:169], v[168:169], v[116:117], v[120:121]
    v_pk_fma_f32 v[170:171], v[170:171], v[118:119], v[122:123]
    v_cvt_pk_bf16_f32 v168, v168, v169
    v_cvt_pk_bf16_f32 v169, v170, v171
    ds_write_b64 v131, v[168:169] offset:1152
    v_cvt_f32_i32 v172, v172
    v_cvt_f32_i32 v173, v173
    v_cvt_f32_i32 v174, v174
    v_cvt_f32_i32 v175, v175
    v_pk_fma_f32 v[172:173], v[172:173], v[116:117], v[120:121]
    v_pk_fma_f32 v[174:175], v[174:175], v[118:119], v[122:123]
    v_cvt_pk_bf16_f32 v172, v172, v173
    v_cvt_pk_bf16_f32 v173, v174, v175
    ds_write_b64 v131, v[172:173] offset:1728
    s_waitcnt vmcnt(16)
    v_cvt_f32_i32 v176, v176
    v_cvt_f32_i32 v177, v177
    v_cvt_f32_i32 v178, v178
    v_cvt_f32_i32 v179, v179
    v_pk_fma_f32 v[176:177], v[176:177], v[116:117], v[120:121]
    v_pk_fma_f32 v[178:179], v[178:179], v[118:119], v[122:123]
    v_cvt_pk_bf16_f32 v176, v176, v177
    v_cvt_pk_bf16_f32 v177, v178, v179
    ds_write_b64 v131, v[176:177] offset:2304
    v_cvt_f32_i32 v180, v180
    v_cvt_f32_i32 v181, v181
    v_cvt_f32_i32 v182, v182
    v_cvt_f32_i32 v183, v183
    v_pk_fma_f32 v[180:181], v[180:181], v[116:117], v[120:121]
    v_pk_fma_f32 v[182:183], v[182:183], v[118:119], v[122:123]
    v_cvt_pk_bf16_f32 v180, v180, v181
    v_cvt_pk_bf16_f32 v181, v182, v183
    ds_write_b64 v131, v[180:181] offset:2880
    v_cvt_f32_i32 v184, v184
    v_cvt_f32_i32 v185, v185
    v_cvt_f32_i32 v186, v186
    v_cvt_f32_i32 v187, v187
    v_pk_fma_f32 v[184:185], v[184:185], v[116:117], v[120:121]
    v_pk_fma_f32 v[186:187], v[186:187], v[118:119], v[122:123]
    v_cvt_pk_bf16_f32 v184, v184, v185
    v_cvt_pk_bf16_f32 v185, v186, v187
    ds_write_b64 v131, v[184:185] offset:3456
    v_cvt_f32_i32 v188, v188
    v_cvt_f32_i32 v189, v189
    v_cvt_f32_i32 v190, v190
    v_cvt_f32_i32 v191, v191
    v_pk_fma_f32 v[188:189], v[188:189], v[116:117], v[120:121]
    v_pk_fma_f32 v[190:191], v[190:191], v[118:119], v[122:123]
    v_cvt_pk_bf16_f32 v188, v188, v189
    v_cvt_pk_bf16_f32 v189, v190, v191
    ds_write_b64 v131, v[188:189] offset:4032
    ds_read_b128 v[100:103], v132 offset:0
    ds_read_b128 v[104:107], v132 offset:64
    ds_read_b128 v[108:111], v132 offset:128
    ds_read_b128 v[112:115], v132 offset:192
    ds_read_b64 v[124:125], v134 offset:18944
    ds_read_b64 v[126:127], v134 offset:20992
    s_add_u32 s5, s4, 0x410000
    s_waitcnt vmcnt(1)
    buffer_load_dwordx4 v[160:163], v128, s[36:39], s5 offen offset:0 nt
    buffer_load_dwordx4 v[164:167], v128, s[36:39], s5 offen offset:1024 nt
    buffer_load_dwordx4 v[168:171], v128, s[36:39], s5 offen offset:2048 nt
    buffer_load_dwordx4 v[172:175], v128, s[36:39], s5 offen offset:3072 nt
    buffer_load_dwordx4 v[176:179], v129, s[36:39], s5 offen offset:0 nt
    buffer_load_dwordx4 v[180:183], v129, s[36:39], s5 offen offset:1024 nt
    buffer_load_dwordx4 v[184:187], v129, s[36:39], s5 offen offset:2048 nt
    buffer_load_dwordx4 v[188:191], v129, s[36:39], s5 offen offset:3072 nt
    s_waitcnt lgkmcnt(5)
    v_mfma_f32_16x16x32_bf16 v[44:47], v[100:103], v[0:3], 0
    s_waitcnt lgkmcnt(4)
    v_mfma_f32_16x16x32_bf16 v[44:47], v[104:107], v[4:7], v[44:47]
    s_waitcnt lgkmcnt(3)
    v_mfma_f32_16x16x32_bf16 v[44:47], v[108:111], v[8:11], v[44:47]
    s_waitcnt lgkmcnt(2)
    v_mfma_f32_16x16x32_bf16 v[44:47], v[112:115], v[12:15], v[44:47]
    s_waitcnt lgkmcnt(0)
    v_lshlrev_b32 v116, 16, v124
    v_and_b32 v117, s14, v124
    v_lshlrev_b32 v118, 16, v125
    v_and_b32 v119, s14, v125
    v_lshlrev_b32 v120, 16, v126
    v_and_b32 v121, s14, v126
    v_lshlrev_b32 v122, 16, v127
    v_and_b32 v123, s14, v127
    v_mul_f32 v120, -v120, v116
    v_mul_f32 v121, -v121, v117
    v_mul_f32 v122, -v122, v118
    v_mul_f32 v123, -v123, v119
    v_max3_f32 v156, v156, v40, v41
    v_max3_f32 v157, v157, v42, v43
    s_waitcnt vmcnt(20)
    v_cvt_f32_i32 v192, v192
    v_cvt_f32_i32 v193, v193
    v_cvt_f32_i32 v194, v194
    v_cvt_f32_i32 v195, v195
    v_pk_fma_f32 v[192:193], v[192:193], v[116:117], v[120:121]
    v_pk_fma_f32 v[194:195], v[194:195], v[118:119], v[122:123]
    v_cvt_pk_bf16_f32 v192, v192, v193
    v_cvt_pk_bf16_f32 v193, v194, v195
    ds_write_b64 v131, v[192:193] offset:0
    v_cvt_f32_i32 v196, v196
    v_cvt_f32_i32 v197, v197
    v_cvt_f32_i32 v198, v198
    v_cvt_f32_i32 v199, v199
    v_pk_fma_f32 v[196:197], v[196:197], v[116:117], v[120:121]
    v_pk_fma_f32 v[198:199], v[198:199], v[118:119], v[122:123]
    v_cvt_pk_bf16_f32 v196, v196, v197
    v_cvt_pk_bf16_f32 v197, v198, v199
    ds_write_b64 v131, v[196:197] offset:576
    v_cvt_f32_i32 v200, v200
    v_cvt_f32_i32 v201, v201
    v_cvt_f32_i32 v202, v202
    v_cvt_f32_i32 v203, v203
    v_pk_fma_f32 v[200:201], v[200:201], v[116:117], v[120:121]
    v_pk_fma_f32 v[202:203], v[202:203], v[118:119], v[122:123]
    v_cvt_pk_bf16_f32 v200, v200, v201
    v_cvt_pk_bf16_f32 v201, v202, v203
    ds_write_b64 v131, v[200:201] offset:1152
    v_cvt_f32_i32 v204, v204
    v_cvt_f32_i32 v205, v205
    v_cvt_f32_i32 v206, v206
    v_cvt_f32_i32 v207, v207
    v_pk_fma_f32 v[204:205], v[204:205], v[116:117], v[120:121]
    v_pk_fma_f32 v[206:207], v[206:207], v[118:119], v[122:123]
    v_cvt_pk_bf16_f32 v204, v204, v205
    v_cvt_pk_bf16_f32 v205, v206, v207
    ds_write_b64 v131, v[204:205] offset:1728
    s_waitcnt vmcnt(16)
    v_cvt_f32_i32 v208, v208
    v_cvt_f32_i32 v209, v209
    v_cvt_f32_i32 v210, v210
    v_cvt_f32_i32 v211, v211
    v_pk_fma_f32 v[208:209], v[208:209], v[116:117], v[120:121]
    v_pk_fma_f32 v[210:211], v[210:211], v[118:119], v[122:123]
    v_cvt_pk_bf16_f32 v208, v208, v209
    v_cvt_pk_bf16_f32 v209, v210, v211
    ds_write_b64 v131, v[208:209] offset:2304
    v_cvt_f32_i32 v212, v212
    v_cvt_f32_i32 v213, v213
    v_cvt_f32_i32 v214, v214
    v_cvt_f32_i32 v215, v215
    v_pk_fma_f32 v[212:213], v[212:213], v[116:117], v[120:121]
    v_pk_fma_f32 v[214:215], v[214:215], v[118:119], v[122:123]
    v_cvt_pk_bf16_f32 v212, v212, v213
    v_cvt_pk_bf16_f32 v213, v214, v215
    ds_write_b64 v131, v[212:213] offset:2880
    v_cvt_f32_i32 v216, v216
    v_cvt_f32_i32 v217, v217
    v_cvt_f32_i32 v218, v218
    v_cvt_f32_i32 v219, v219
    v_pk_fma_f32 v[216:217], v[216:217], v[116:117], v[120:121]
    v_pk_fma_f32 v[218:219], v[218:219], v[118:119], v[122:123]
    v_cvt_pk_bf16_f32 v216, v216, v217
    v_cvt_pk_bf16_f32 v217, v218, v219
    ds_write_b64 v131, v[216:217] offset:3456
    v_cvt_f32_i32 v220, v220
    v_cvt_f32_i32 v221, v221
    v_cvt_f32_i32 v222, v222
    v_cvt_f32_i32 v223, v223
    v_pk_fma_f32 v[220:221], v[220:221], v[116:117], v[120:121]
    v_pk_fma_f32 v[222:223], v[222:223], v[118:119], v[122:123]
    v_cvt_pk_bf16_f32 v220, v220, v221
    v_cvt_pk_bf16_f32 v221, v222, v223
    ds_write_b64 v131, v[220:221] offset:4032
    ds_read_b128 v[100:103], v132 offset:0
    ds_read_b128 v[104:107], v132 offset:64
    ds_read_b128 v[108:111], v132 offset:128
    ds_read_b128 v[112:115], v132 offset:192
    s_add_u32 s6, s4, 0x418000
    s_waitcnt vmcnt(1)
    buffer_load_dwordx4 v[192:195], v128, s[36:39], s6 offen offset:0 nt
    buffer_load_dwordx4 v[196:199], v128, s[36:39], s6 offen offset:1024 nt
    buffer_load_dwordx4 v[200:203], v128, s[36:39], s6 offen offset:2048 nt
    buffer_load_dwordx4 v[204:207], v128, s[36:39], s6 offen offset:3072 nt
    buffer_load_dwordx4 v[208:211], v129, s[36:39], s6 offen offset:0 nt
    buffer_load_dwordx4 v[212:215], v129, s[36:39], s6 offen offset:1024 nt
    buffer_load_dwordx4 v[216:219], v129, s[36:39], s6 offen offset:2048 nt
    buffer_load_dwordx4 v[220:223], v129, s[36:39], s6 offen offset:3072 nt
    s_waitcnt lgkmcnt(3)
    v_mfma_f32_16x16x32_bf16 v[48:51], v[100:103], v[0:3], 0
    s_waitcnt lgkmcnt(2)
    v_mfma_f32_16x16x32_bf16 v[48:51], v[104:107], v[4:7], v[48:51]
    s_waitcnt lgkmcnt(1)
    v_mfma_f32_16x16x32_bf16 v[48:51], v[108:111], v[8:11], v[48:51]
    s_waitcnt lgkmcnt(0)
    v_mfma_f32_16x16x32_bf16 v[48:51], v[112:115], v[12:15], v[48:51]
    v_max3_f32 v156, v156, v44, v45
    v_max3_f32 v157, v157, v46, v47
    s_waitcnt vmcnt(20)
    v_cvt_f32_i32 v224, v224
    v_cvt_f32_i32 v225, v225
    v_cvt_f32_i32 v226, v226
    v_cvt_f32_i32 v227, v227
    v_pk_fma_f32 v[224:225], v[224:225], v[116:117], v[120:121]
    v_pk_fma_f32 v[226:227], v[226:227], v[118:119], v[122:123]
    v_cvt_pk_bf16_f32 v224, v224, v225
    v_cvt_pk_bf16_f32 v225, v226, v227
    ds_write_b64 v131, v[224:225] offset:0
    v_cvt_f32_i32 v228, v228
    v_cvt_f32_i32 v229, v229
    v_cvt_f32_i32 v230, v230
    v_cvt_f32_i32 v231, v231
    v_pk_fma_f32 v[228:229], v[228:229], v[116:117], v[120:121]
    v_pk_fma_f32 v[230:231], v[230:231], v[118:119], v[122:123]
    v_cvt_pk_bf16_f32 v228, v228, v229
    v_cvt_pk_bf16_f32 v229, v230, v231
    ds_write_b64 v131, v[228:229] offset:576
    v_cvt_f32_i32 v232, v232
    v_cvt_f32_i32 v233, v233
    v_cvt_f32_i32 v234, v234
    v_cvt_f32_i32 v235, v235
    v_pk_fma_f32 v[232:233], v[232:233], v[116:117], v[120:121]
    v_pk_fma_f32 v[234:235], v[234:235], v[118:119], v[122:123]
    v_cvt_pk_bf16_f32 v232, v232, v233
    v_cvt_pk_bf16_f32 v233, v234, v235
    ds_write_b64 v131, v[232:233] offset:1152
    v_cvt_f32_i32 v236, v236
    v_cvt_f32_i32 v237, v237
    v_cvt_f32_i32 v238, v238
    v_cvt_f32_i32 v239, v239
    v_pk_fma_f32 v[236:237], v[236:237], v[116:117], v[120:121]
    v_pk_fma_f32 v[238:239], v[238:239], v[118:119], v[122:123]
    v_cvt_pk_bf16_f32 v236, v236, v237
    v_cvt_pk_bf16_f32 v237, v238, v239
    ds_write_b64 v131, v[236:237] offset:1728
    s_waitcnt vmcnt(16)
    v_cvt_f32_i32 v240, v240
    v_cvt_f32_i32 v241, v241
    v_cvt_f32_i32 v242, v242
    v_cvt_f32_i32 v243, v243
    v_pk_fma_f32 v[240:241], v[240:241], v[116:117], v[120:121]
    v_pk_fma_f32 v[242:243], v[242:243], v[118:119], v[122:123]
    v_cvt_pk_bf16_f32 v240, v240, v241
    v_cvt_pk_bf16_f32 v241, v242, v243
    ds_write_b64 v131, v[240:241] offset:2304
    v_cvt_f32_i32 v244, v244
    v_cvt_f32_i32 v245, v245
    v_cvt_f32_i32 v246, v246
    v_cvt_f32_i32 v247, v247
    v_pk_fma_f32 v[244:245], v[244:245], v[116:117], v[120:121]
    v_pk_fma_f32 v[246:247], v[246:247], v[118:119], v[122:123]
    v_cvt_pk_bf16_f32 v244, v244, v245
    v_cvt_pk_bf16_f32 v245, v246, v247
    ds_write_b64 v131, v[244:245] offset:2880
    v_cvt_f32_i32 v248, v248
    v_cvt_f32_i32 v249, v249
    v_cvt_f32_i32 v250, v250
    v_cvt_f32_i32 v251, v251
    v_pk_fma_f32 v[248:249], v[248:249], v[116:117], v[120:121]
    v_pk_fma_f32 v[250:251], v[250:251], v[118:119], v[122:123]
    v_cvt_pk_bf16_f32 v248, v248, v249
    v_cvt_pk_bf16_f32 v249, v250, v251
    ds_write_b64 v131, v[248:249] offset:3456
    v_cvt_f32_i32 v252, v252
    v_cvt_f32_i32 v253, v253
    v_cvt_f32_i32 v254, v254
    v_cvt_f32_i32 v255, v255
    v_pk_fma_f32 v[252:253], v[252:253], v[116:117], v[120:121]
    v_pk_fma_f32 v[254:255], v[254:255], v[118:119], v[122:123]
    v_cvt_pk_bf16_f32 v252, v252, v253
    v_cvt_pk_bf16_f32 v253, v254, v255
    ds_write_b64 v131, v[252:253] offset:4032
    ds_read_b128 v[100:103], v132 offset:0
    ds_read_b128 v[104:107], v132 offset:64
    ds_read_b128 v[108:111], v132 offset:128
    ds_read_b128 v[112:115], v132 offset:192
    ds_read_b64 v[124:125], v134 offset:19200
    ds_read_b64 v[126:127], v134 offset:21248
    s_add_u32 s5, s4, 0x800000
    s_waitcnt vmcnt(1)
    buffer_load_dwordx4 v[224:227], v128, s[36:39], s5 offen offset:0 nt
    buffer_load_dwordx4 v[228:231], v128, s[36:39], s5 offen offset:1024 nt
    buffer_load_dwordx4 v[232:235], v128, s[36:39], s5 offen offset:2048 nt
    buffer_load_dwordx4 v[236:239], v128, s[36:39], s5 offen offset:3072 nt
    buffer_load_dwordx4 v[240:243], v129, s[36:39], s5 offen offset:0 nt
    buffer_load_dwordx4 v[244:247], v129, s[36:39], s5 offen offset:1024 nt
    buffer_load_dwordx4 v[248:251], v129, s[36:39], s5 offen offset:2048 nt
    buffer_load_dwordx4 v[252:255], v129, s[36:39], s5 offen offset:3072 nt
    s_waitcnt lgkmcnt(5)
    v_mfma_f32_16x16x32_bf16 v[52:55], v[100:103], v[0:3], 0
    s_waitcnt lgkmcnt(4)
    v_mfma_f32_16x16x32_bf16 v[52:55], v[104:107], v[4:7], v[52:55]
    s_waitcnt lgkmcnt(3)
    v_mfma_f32_16x16x32_bf16 v[52:55], v[108:111], v[8:11], v[52:55]
    s_waitcnt lgkmcnt(2)
    v_mfma_f32_16x16x32_bf16 v[52:55], v[112:115], v[12:15], v[52:55]
    s_waitcnt lgkmcnt(0)
    v_lshlrev_b32 v116, 16, v124
    v_and_b32 v117, s14, v124
    v_lshlrev_b32 v118, 16, v125
    v_and_b32 v119, s14, v125
    v_lshlrev_b32 v120, 16, v126
    v_and_b32 v121, s14, v126
    v_lshlrev_b32 v122, 16, v127
    v_and_b32 v123, s14, v127
    v_mul_f32 v120, -v120, v116
    v_mul_f32 v121, -v121, v117
    v_mul_f32 v122, -v122, v118
    v_mul_f32 v123, -v123, v119
    v_max3_f32 v156, v156, v48, v49
    v_max3_f32 v157, v157, v50, v51
    s_waitcnt vmcnt(20)
    v_cvt_f32_i32 v160, v160
    v_cvt_f32_i32 v161, v161
    v_cvt_f32_i32 v162, v162
    v_cvt_f32_i32 v163, v163
    v_pk_fma_f32 v[160:161], v[160:161], v[116:117], v[120:121]
    v_pk_fma_f32 v[162:163], v[162:163], v[118:119], v[122:123]
    v_cvt_pk_bf16_f32 v160, v160, v161
    v_cvt_pk_bf16_f32 v161, v162, v163
    ds_write_b64 v131, v[160:161] offset:0
    v_cvt_f32_i32 v164, v164
    v_cvt_f32_i32 v165, v165
    v_cvt_f32_i32 v166, v166
    v_cvt_f32_i32 v167, v167
    v_pk_fma_f32 v[164:165], v[164:165], v[116:117], v[120:121]
    v_pk_fma_f32 v[166:167], v[166:167], v[118:119], v[122:123]
    v_cvt_pk_bf16_f32 v164, v164, v165
    v_cvt_pk_bf16_f32 v165, v166, v167
    ds_write_b64 v131, v[164:165] offset:576
    v_cvt_f32_i32 v168, v168
    v_cvt_f32_i32 v169, v169
    v_cvt_f32_i32 v170, v170
    v_cvt_f32_i32 v171, v171
    v_pk_fma_f32 v[168:169], v[168:169], v[116:117], v[120:121]
    v_pk_fma_f32 v[170:171], v[170:171], v[118:119], v[122:123]
    v_cvt_pk_bf16_f32 v168, v168, v169
    v_cvt_pk_bf16_f32 v169, v170, v171
    ds_write_b64 v131, v[168:169] offset:1152
    v_cvt_f32_i32 v172, v172
    v_cvt_f32_i32 v173, v173
    v_cvt_f32_i32 v174, v174
    v_cvt_f32_i32 v175, v175
    v_pk_fma_f32 v[172:173], v[172:173], v[116:117], v[120:121]
    v_pk_fma_f32 v[174:175], v[174:175], v[118:119], v[122:123]
    v_cvt_pk_bf16_f32 v172, v172, v173
    v_cvt_pk_bf16_f32 v173, v174, v175
    ds_write_b64 v131, v[172:173] offset:1728
    s_waitcnt vmcnt(16)
    v_cvt_f32_i32 v176, v176
    v_cvt_f32_i32 v177, v177
    v_cvt_f32_i32 v178, v178
    v_cvt_f32_i32 v179, v179
    v_pk_fma_f32 v[176:177], v[176:177], v[116:117], v[120:121]
    v_pk_fma_f32 v[178:179], v[178:179], v[118:119], v[122:123]
    v_cvt_pk_bf16_f32 v176, v176, v177
    v_cvt_pk_bf16_f32 v177, v178, v179
    ds_write_b64 v131, v[176:177] offset:2304
    v_cvt_f32_i32 v180, v180
    v_cvt_f32_i32 v181, v181
    v_cvt_f32_i32 v182, v182
    v_cvt_f32_i32 v183, v183
    v_pk_fma_f32 v[180:181], v[180:181], v[116:117], v[120:121]
    v_pk_fma_f32 v[182:183], v[182:183], v[118:119], v[122:123]
    v_cvt_pk_bf16_f32 v180, v180, v181
    v_cvt_pk_bf16_f32 v181, v182, v183
    ds_write_b64 v131, v[180:181] offset:2880
    v_cvt_f32_i32 v184, v184
    v_cvt_f32_i32 v185, v185
    v_cvt_f32_i32 v186, v186
    v_cvt_f32_i32 v187, v187
    v_pk_fma_f32 v[184:185], v[184:185], v[116:117], v[120:121]
    v_pk_fma_f32 v[186:187], v[186:187], v[118:119], v[122:123]
    v_cvt_pk_bf16_f32 v184, v184, v185
    v_cvt_pk_bf16_f32 v185, v186, v187
    ds_write_b64 v131, v[184:185] offset:3456
    v_cvt_f32_i32 v188, v188
    v_cvt_f32_i32 v189, v189
    v_cvt_f32_i32 v190, v190
    v_cvt_f32_i32 v191, v191
    v_pk_fma_f32 v[188:189], v[188:189], v[116:117], v[120:121]
    v_pk_fma_f32 v[190:191], v[190:191], v[118:119], v[122:123]
    v_cvt_pk_bf16_f32 v188, v188, v189
    v_cvt_pk_bf16_f32 v189, v190, v191
    ds_write_b64 v131, v[188:189] offset:4032
    ds_read_b128 v[100:103], v132 offset:0
    ds_read_b128 v[104:107], v132 offset:64
    ds_read_b128 v[108:111], v132 offset:128
    ds_read_b128 v[112:115], v132 offset:192
    s_add_u32 s6, s4, 0x808000
    s_waitcnt vmcnt(1)
    buffer_load_dwordx4 v[160:163], v128, s[36:39], s6 offen offset:0 nt
    buffer_load_dwordx4 v[164:167], v128, s[36:39], s6 offen offset:1024 nt
    buffer_load_dwordx4 v[168:171], v128, s[36:39], s6 offen offset:2048 nt
    buffer_load_dwordx4 v[172:175], v128, s[36:39], s6 offen offset:3072 nt
    buffer_load_dwordx4 v[176:179], v129, s[36:39], s6 offen offset:0 nt
    buffer_load_dwordx4 v[180:183], v129, s[36:39], s6 offen offset:1024 nt
    buffer_load_dwordx4 v[184:187], v129, s[36:39], s6 offen offset:2048 nt
    buffer_load_dwordx4 v[188:191], v129, s[36:39], s6 offen offset:3072 nt
    s_waitcnt lgkmcnt(3)
    v_mfma_f32_16x16x32_bf16 v[56:59], v[100:103], v[0:3], 0
    s_waitcnt lgkmcnt(2)
    v_mfma_f32_16x16x32_bf16 v[56:59], v[104:107], v[4:7], v[56:59]
    s_waitcnt lgkmcnt(1)
    v_mfma_f32_16x16x32_bf16 v[56:59], v[108:111], v[8:11], v[56:59]
    s_waitcnt lgkmcnt(0)
    v_mfma_f32_16x16x32_bf16 v[56:59], v[112:115], v[12:15], v[56:59]
    v_max3_f32 v156, v156, v52, v53
    v_max3_f32 v157, v157, v54, v55
    s_waitcnt vmcnt(20)
    v_cvt_f32_i32 v192, v192
    v_cvt_f32_i32 v193, v193
    v_cvt_f32_i32 v194, v194
    v_cvt_f32_i32 v195, v195
    v_pk_fma_f32 v[192:193], v[192:193], v[116:117], v[120:121]
    v_pk_fma_f32 v[194:195], v[194:195], v[118:119], v[122:123]
    v_cvt_pk_bf16_f32 v192, v192, v193
    v_cvt_pk_bf16_f32 v193, v194, v195
    ds_write_b64 v131, v[192:193] offset:0
    v_cvt_f32_i32 v196, v196
    v_cvt_f32_i32 v197, v197
    v_cvt_f32_i32 v198, v198
    v_cvt_f32_i32 v199, v199
    v_pk_fma_f32 v[196:197], v[196:197], v[116:117], v[120:121]
    v_pk_fma_f32 v[198:199], v[198:199], v[118:119], v[122:123]
    v_cvt_pk_bf16_f32 v196, v196, v197
    v_cvt_pk_bf16_f32 v197, v198, v199
    ds_write_b64 v131, v[196:197] offset:576
    v_cvt_f32_i32 v200, v200
    v_cvt_f32_i32 v201, v201
    v_cvt_f32_i32 v202, v202
    v_cvt_f32_i32 v203, v203
    v_pk_fma_f32 v[200:201], v[200:201], v[116:117], v[120:121]
    v_pk_fma_f32 v[202:203], v[202:203], v[118:119], v[122:123]
    v_cvt_pk_bf16_f32 v200, v200, v201
    v_cvt_pk_bf16_f32 v201, v202, v203
    ds_write_b64 v131, v[200:201] offset:1152
    v_cvt_f32_i32 v204, v204
    v_cvt_f32_i32 v205, v205
    v_cvt_f32_i32 v206, v206
    v_cvt_f32_i32 v207, v207
    v_pk_fma_f32 v[204:205], v[204:205], v[116:117], v[120:121]
    v_pk_fma_f32 v[206:207], v[206:207], v[118:119], v[122:123]
    v_cvt_pk_bf16_f32 v204, v204, v205
    v_cvt_pk_bf16_f32 v205, v206, v207
    ds_write_b64 v131, v[204:205] offset:1728
    s_waitcnt vmcnt(16)
    v_cvt_f32_i32 v208, v208
    v_cvt_f32_i32 v209, v209
    v_cvt_f32_i32 v210, v210
    v_cvt_f32_i32 v211, v211
    v_pk_fma_f32 v[208:209], v[208:209], v[116:117], v[120:121]
    v_pk_fma_f32 v[210:211], v[210:211], v[118:119], v[122:123]
    v_cvt_pk_bf16_f32 v208, v208, v209
    v_cvt_pk_bf16_f32 v209, v210, v211
    ds_write_b64 v131, v[208:209] offset:2304
    v_cvt_f32_i32 v212, v212
    v_cvt_f32_i32 v213, v213
    v_cvt_f32_i32 v214, v214
    v_cvt_f32_i32 v215, v215
    v_pk_fma_f32 v[212:213], v[212:213], v[116:117], v[120:121]
    v_pk_fma_f32 v[214:215], v[214:215], v[118:119], v[122:123]
    v_cvt_pk_bf16_f32 v212, v212, v213
    v_cvt_pk_bf16_f32 v213, v214, v215
    ds_write_b64 v131, v[212:213] offset:2880
    v_cvt_f32_i32 v216, v216
    v_cvt_f32_i32 v217, v217
    v_cvt_f32_i32 v218, v218
    v_cvt_f32_i32 v219, v219
    v_pk_fma_f32 v[216:217], v[216:217], v[116:117], v[120:121]
    v_pk_fma_f32 v[218:219], v[218:219], v[118:119], v[122:123]
    v_cvt_pk_bf16_f32 v216, v216, v217
    v_cvt_pk_bf16_f32 v217, v218, v219
    ds_write_b64 v131, v[216:217] offset:3456
    v_cvt_f32_i32 v220, v220
    v_cvt_f32_i32 v221, v221
    v_cvt_f32_i32 v222, v222
    v_cvt_f32_i32 v223, v223
    v_pk_fma_f32 v[220:221], v[220:221], v[116:117], v[120:121]
    v_pk_fma_f32 v[222:223], v[222:223], v[118:119], v[122:123]
    v_cvt_pk_bf16_f32 v220, v220, v221
    v_cvt_pk_bf16_f32 v221, v222, v223
    ds_write_b64 v131, v[220:221] offset:4032
    ds_read_b128 v[100:103], v132 offset:0
    ds_read_b128 v[104:107], v132 offset:64
    ds_read_b128 v[108:111], v132 offset:128
    ds_read_b128 v[112:115], v132 offset:192
    ds_read_b64 v[124:125], v134 offset:19456
    ds_read_b64 v[126:127], v134 offset:21504
    s_add_u32 s5, s4, 0x810000
    s_waitcnt vmcnt(1)
    buffer_load_dwordx4 v[192:195], v128, s[36:39], s5 offen offset:0 nt
    buffer_load_dwordx4 v[196:199], v128, s[36:39], s5 offen offset:1024 nt
    buffer_load_dwordx4 v[200:203], v128, s[36:39], s5 offen offset:2048 nt
    buffer_load_dwordx4 v[204:207], v128, s[36:39], s5 offen offset:3072 nt
    buffer_load_dwordx4 v[208:211], v129, s[36:39], s5 offen offset:0 nt
    buffer_load_dwordx4 v[212:215], v129, s[36:39], s5 offen offset:1024 nt
    buffer_load_dwordx4 v[216:219], v129, s[36:39], s5 offen offset:2048 nt
    buffer_load_dwordx4 v[220:223], v129, s[36:39], s5 offen offset:3072 nt
    s_waitcnt lgkmcnt(5)
    v_mfma_f32_16x16x32_bf16 v[60:63], v[100:103], v[0:3], 0
    s_waitcnt lgkmcnt(4)
    v_mfma_f32_16x16x32_bf16 v[60:63], v[104:107], v[4:7], v[60:63]
    s_waitcnt lgkmcnt(3)
    v_mfma_f32_16x16x32_bf16 v[60:63], v[108:111], v[8:11], v[60:63]
    s_waitcnt lgkmcnt(2)
    v_mfma_f32_16x16x32_bf16 v[60:63], v[112:115], v[12:15], v[60:63]
    s_waitcnt lgkmcnt(0)
    v_lshlrev_b32 v116, 16, v124
    v_and_b32 v117, s14, v124
    v_lshlrev_b32 v118, 16, v125
    v_and_b32 v119, s14, v125
    v_lshlrev_b32 v120, 16, v126
    v_and_b32 v121, s14, v126
    v_lshlrev_b32 v122, 16, v127
    v_and_b32 v123, s14, v127
    v_mul_f32 v120, -v120, v116
    v_mul_f32 v121, -v121, v117
    v_mul_f32 v122, -v122, v118
    v_mul_f32 v123, -v123, v119
    v_max3_f32 v156, v156, v56, v57
    v_max3_f32 v157, v157, v58, v59
    s_waitcnt vmcnt(20)
    v_cvt_f32_i32 v224, v224
    v_cvt_f32_i32 v225, v225
    v_cvt_f32_i32 v226, v226
    v_cvt_f32_i32 v227, v227
    v_pk_fma_f32 v[224:225], v[224:225], v[116:117], v[120:121]
    v_pk_fma_f32 v[226:227], v[226:227], v[118:119], v[122:123]
    v_cvt_pk_bf16_f32 v224, v224, v225
    v_cvt_pk_bf16_f32 v225, v226, v227
    ds_write_b64 v131, v[224:225] offset:0
    v_cvt_f32_i32 v228, v228
    v_cvt_f32_i32 v229, v229
    v_cvt_f32_i32 v230, v230
    v_cvt_f32_i32 v231, v231
    v_pk_fma_f32 v[228:229], v[228:229], v[116:117], v[120:121]
    v_pk_fma_f32 v[230:231], v[230:231], v[118:119], v[122:123]
    v_cvt_pk_bf16_f32 v228, v228, v229
    v_cvt_pk_bf16_f32 v229, v230, v231
    ds_write_b64 v131, v[228:229] offset:576
    v_cvt_f32_i32 v232, v232
    v_cvt_f32_i32 v233, v233
    v_cvt_f32_i32 v234, v234
    v_cvt_f32_i32 v235, v235
    v_pk_fma_f32 v[232:233], v[232:233], v[116:117], v[120:121]
    v_pk_fma_f32 v[234:235], v[234:235], v[118:119], v[122:123]
    v_cvt_pk_bf16_f32 v232, v232, v233
    v_cvt_pk_bf16_f32 v233, v234, v235
    ds_write_b64 v131, v[232:233] offset:1152
    v_cvt_f32_i32 v236, v236
    v_cvt_f32_i32 v237, v237
    v_cvt_f32_i32 v238, v238
    v_cvt_f32_i32 v239, v239
    v_pk_fma_f32 v[236:237], v[236:237], v[116:117], v[120:121]
    v_pk_fma_f32 v[238:239], v[238:239], v[118:119], v[122:123]
    v_cvt_pk_bf16_f32 v236, v236, v237
    v_cvt_pk_bf16_f32 v237, v238, v239
    ds_write_b64 v131, v[236:237] offset:1728
    s_waitcnt vmcnt(16)
    v_cvt_f32_i32 v240, v240
    v_cvt_f32_i32 v241, v241
    v_cvt_f32_i32 v242, v242
    v_cvt_f32_i32 v243, v243
    v_pk_fma_f32 v[240:241], v[240:241], v[116:117], v[120:121]
    v_pk_fma_f32 v[242:243], v[242:243], v[118:119], v[122:123]
    v_cvt_pk_bf16_f32 v240, v240, v241
    v_cvt_pk_bf16_f32 v241, v242, v243
    ds_write_b64 v131, v[240:241] offset:2304
    v_cvt_f32_i32 v244, v244
    v_cvt_f32_i32 v245, v245
    v_cvt_f32_i32 v246, v246
    v_cvt_f32_i32 v247, v247
    v_pk_fma_f32 v[244:245], v[244:245], v[116:117], v[120:121]
    v_pk_fma_f32 v[246:247], v[246:247], v[118:119], v[122:123]
    v_cvt_pk_bf16_f32 v244, v244, v245
    v_cvt_pk_bf16_f32 v245, v246, v247
    ds_write_b64 v131, v[244:245] offset:2880
    v_cvt_f32_i32 v248, v248
    v_cvt_f32_i32 v249, v249
    v_cvt_f32_i32 v250, v250
    v_cvt_f32_i32 v251, v251
    v_pk_fma_f32 v[248:249], v[248:249], v[116:117], v[120:121]
    v_pk_fma_f32 v[250:251], v[250:251], v[118:119], v[122:123]
    v_cvt_pk_bf16_f32 v248, v248, v249
    v_cvt_pk_bf16_f32 v249, v250, v251
    ds_write_b64 v131, v[248:249] offset:3456
    v_cvt_f32_i32 v252, v252
    v_cvt_f32_i32 v253, v253
    v_cvt_f32_i32 v254, v254
    v_cvt_f32_i32 v255, v255
    v_pk_fma_f32 v[252:253], v[252:253], v[116:117], v[120:121]
    v_pk_fma_f32 v[254:255], v[254:255], v[118:119], v[122:123]
    v_cvt_pk_bf16_f32 v252, v252, v253
    v_cvt_pk_bf16_f32 v253, v254, v255
    ds_write_b64 v131, v[252:253] offset:4032
    ds_read_b128 v[100:103], v132 offset:0
    ds_read_b128 v[104:107], v132 offset:64
    ds_read_b128 v[108:111], v132 offset:128
    ds_read_b128 v[112:115], v132 offset:192
    s_add_u32 s6, s4, 0x818000
    s_waitcnt vmcnt(1)
    buffer_load_dwordx4 v[224:227], v128, s[36:39], s6 offen offset:0 nt
    buffer_load_dwordx4 v[228:231], v128, s[36:39], s6 offen offset:1024 nt
    buffer_load_dwordx4 v[232:235], v128, s[36:39], s6 offen offset:2048 nt
    buffer_load_dwordx4 v[236:239], v128, s[36:39], s6 offen offset:3072 nt
    buffer_load_dwordx4 v[240:243], v129, s[36:39], s6 offen offset:0 nt
    buffer_load_dwordx4 v[244:247], v129, s[36:39], s6 offen offset:1024 nt
    buffer_load_dwordx4 v[248:251], v129, s[36:39], s6 offen offset:2048 nt
    buffer_load_dwordx4 v[252:255], v129, s[36:39], s6 offen offset:3072 nt
    s_waitcnt lgkmcnt(3)
    v_mfma_f32_16x16x32_bf16 v[64:67], v[100:103], v[0:3], 0
    s_waitcnt lgkmcnt(2)
    v_mfma_f32_16x16x32_bf16 v[64:67], v[104:107], v[4:7], v[64:67]
    s_waitcnt lgkmcnt(1)
    v_mfma_f32_16x16x32_bf16 v[64:67], v[108:111], v[8:11], v[64:67]
    s_waitcnt lgkmcnt(0)
    v_mfma_f32_16x16x32_bf16 v[64:67], v[112:115], v[12:15], v[64:67]
    v_max3_f32 v156, v156, v60, v61
    v_max3_f32 v157, v157, v62, v63
    s_waitcnt vmcnt(20)
    v_cvt_f32_i32 v160, v160
    v_cvt_f32_i32 v161, v161
    v_cvt_f32_i32 v162, v162
    v_cvt_f32_i32 v163, v163
    v_pk_fma_f32 v[160:161], v[160:161], v[116:117], v[120:121]
    v_pk_fma_f32 v[162:163], v[162:163], v[118:119], v[122:123]
    v_cvt_pk_bf16_f32 v160, v160, v161
    v_cvt_pk_bf16_f32 v161, v162, v163
    ds_write_b64 v131, v[160:161] offset:0
    v_cvt_f32_i32 v164, v164
    v_cvt_f32_i32 v165, v165
    v_cvt_f32_i32 v166, v166
    v_cvt_f32_i32 v167, v167
    v_pk_fma_f32 v[164:165], v[164:165], v[116:117], v[120:121]
    v_pk_fma_f32 v[166:167], v[166:167], v[118:119], v[122:123]
    v_cvt_pk_bf16_f32 v164, v164, v165
    v_cvt_pk_bf16_f32 v165, v166, v167
    ds_write_b64 v131, v[164:165] offset:576
    v_cvt_f32_i32 v168, v168
    v_cvt_f32_i32 v169, v169
    v_cvt_f32_i32 v170, v170
    v_cvt_f32_i32 v171, v171
    v_pk_fma_f32 v[168:169], v[168:169], v[116:117], v[120:121]
    v_pk_fma_f32 v[170:171], v[170:171], v[118:119], v[122:123]
    v_cvt_pk_bf16_f32 v168, v168, v169
    v_cvt_pk_bf16_f32 v169, v170, v171
    ds_write_b64 v131, v[168:169] offset:1152
    v_cvt_f32_i32 v172, v172
    v_cvt_f32_i32 v173, v173
    v_cvt_f32_i32 v174, v174
    v_cvt_f32_i32 v175, v175
    v_pk_fma_f32 v[172:173], v[172:173], v[116:117], v[120:121]
    v_pk_fma_f32 v[174:175], v[174:175], v[118:119], v[122:123]
    v_cvt_pk_bf16_f32 v172, v172, v173
    v_cvt_pk_bf16_f32 v173, v174, v175
    ds_write_b64 v131, v[172:173] offset:1728
    s_waitcnt vmcnt(16)
    v_cvt_f32_i32 v176, v176
    v_cvt_f32_i32 v177, v177
    v_cvt_f32_i32 v178, v178
    v_cvt_f32_i32 v179, v179
    v_pk_fma_f32 v[176:177], v[176:177], v[116:117], v[120:121]
    v_pk_fma_f32 v[178:179], v[178:179], v[118:119], v[122:123]
    v_cvt_pk_bf16_f32 v176, v176, v177
    v_cvt_pk_bf16_f32 v177, v178, v179
    ds_write_b64 v131, v[176:177] offset:2304
    v_cvt_f32_i32 v180, v180
    v_cvt_f32_i32 v181, v181
    v_cvt_f32_i32 v182, v182
    v_cvt_f32_i32 v183, v183
    v_pk_fma_f32 v[180:181], v[180:181], v[116:117], v[120:121]
    v_pk_fma_f32 v[182:183], v[182:183], v[118:119], v[122:123]
    v_cvt_pk_bf16_f32 v180, v180, v181
    v_cvt_pk_bf16_f32 v181, v182, v183
    ds_write_b64 v131, v[180:181] offset:2880
    v_cvt_f32_i32 v184, v184
    v_cvt_f32_i32 v185, v185
    v_cvt_f32_i32 v186, v186
    v_cvt_f32_i32 v187, v187
    v_pk_fma_f32 v[184:185], v[184:185], v[116:117], v[120:121]
    v_pk_fma_f32 v[186:187], v[186:187], v[118:119], v[122:123]
    v_cvt_pk_bf16_f32 v184, v184, v185
    v_cvt_pk_bf16_f32 v185, v186, v187
    ds_write_b64 v131, v[184:185] offset:3456
    v_cvt_f32_i32 v188, v188
    v_cvt_f32_i32 v189, v189
    v_cvt_f32_i32 v190, v190
    v_cvt_f32_i32 v191, v191
    v_pk_fma_f32 v[188:189], v[188:189], v[116:117], v[120:121]
    v_pk_fma_f32 v[190:191], v[190:191], v[118:119], v[122:123]
    v_cvt_pk_bf16_f32 v188, v188, v189
    v_cvt_pk_bf16_f32 v189, v190, v191
    ds_write_b64 v131, v[188:189] offset:4032
    ds_read_b128 v[100:103], v132 offset:0
    ds_read_b128 v[104:107], v132 offset:64
    ds_read_b128 v[108:111], v132 offset:128
    ds_read_b128 v[112:115], v132 offset:192
    ds_read_b64 v[124:125], v134 offset:19712
    ds_read_b64 v[126:127], v134 offset:21760
    s_add_u32 s5, s4, 0xc00000
    s_waitcnt vmcnt(1)
    buffer_load_dwordx4 v[160:163], v128, s[36:39], s5 offen offset:0 nt
    buffer_load_dwordx4 v[164:167], v128, s[36:39], s5 offen offset:1024 nt
    buffer_load_dwordx4 v[168:171], v128, s[36:39], s5 offen offset:2048 nt
    buffer_load_dwordx4 v[172:175], v128, s[36:39], s5 offen offset:3072 nt
    buffer_load_dwordx4 v[176:179], v129, s[36:39], s5 offen offset:0 nt
    buffer_load_dwordx4 v[180:183], v129, s[36:39], s5 offen offset:1024 nt
    buffer_load_dwordx4 v[184:187], v129, s[36:39], s5 offen offset:2048 nt
    buffer_load_dwordx4 v[188:191], v129, s[36:39], s5 offen offset:3072 nt
    s_waitcnt lgkmcnt(5)
    v_mfma_f32_16x16x32_bf16 v[68:71], v[100:103], v[0:3], 0
    s_waitcnt lgkmcnt(4)
    v_mfma_f32_16x16x32_bf16 v[68:71], v[104:107], v[4:7], v[68:71]
    s_waitcnt lgkmcnt(3)
    v_mfma_f32_16x16x32_bf16 v[68:71], v[108:111], v[8:11], v[68:71]
    s_waitcnt lgkmcnt(2)
    v_mfma_f32_16x16x32_bf16 v[68:71], v[112:115], v[12:15], v[68:71]
    s_waitcnt lgkmcnt(0)
    v_lshlrev_b32 v116, 16, v124
    v_and_b32 v117, s14, v124
    v_lshlrev_b32 v118, 16, v125
    v_and_b32 v119, s14, v125
    v_lshlrev_b32 v120, 16, v126
    v_and_b32 v121, s14, v126
    v_lshlrev_b32 v122, 16, v127
    v_and_b32 v123, s14, v127
    v_mul_f32 v120, -v120, v116
    v_mul_f32 v121, -v121, v117
    v_mul_f32 v122, -v122, v118
    v_mul_f32 v123, -v123, v119
    v_max3_f32 v156, v156, v64, v65
    v_max3_f32 v157, v157, v66, v67
    s_waitcnt vmcnt(20)
    v_cvt_f32_i32 v192, v192
    v_cvt_f32_i32 v193, v193
    v_cvt_f32_i32 v194, v194
    v_cvt_f32_i32 v195, v195
    v_pk_fma_f32 v[192:193], v[192:193], v[116:117], v[120:121]
    v_pk_fma_f32 v[194:195], v[194:195], v[118:119], v[122:123]
    v_cvt_pk_bf16_f32 v192, v192, v193
    v_cvt_pk_bf16_f32 v193, v194, v195
    ds_write_b64 v131, v[192:193] offset:0
    v_cvt_f32_i32 v196, v196
    v_cvt_f32_i32 v197, v197
    v_cvt_f32_i32 v198, v198
    v_cvt_f32_i32 v199, v199
    v_pk_fma_f32 v[196:197], v[196:197], v[116:117], v[120:121]
    v_pk_fma_f32 v[198:199], v[198:199], v[118:119], v[122:123]
    v_cvt_pk_bf16_f32 v196, v196, v197
    v_cvt_pk_bf16_f32 v197, v198, v199
    ds_write_b64 v131, v[196:197] offset:576
    v_cvt_f32_i32 v200, v200
    v_cvt_f32_i32 v201, v201
    v_cvt_f32_i32 v202, v202
    v_cvt_f32_i32 v203, v203
    v_pk_fma_f32 v[200:201], v[200:201], v[116:117], v[120:121]
    v_pk_fma_f32 v[202:203], v[202:203], v[118:119], v[122:123]
    v_cvt_pk_bf16_f32 v200, v200, v201
    v_cvt_pk_bf16_f32 v201, v202, v203
    ds_write_b64 v131, v[200:201] offset:1152
    v_cvt_f32_i32 v204, v204
    v_cvt_f32_i32 v205, v205
    v_cvt_f32_i32 v206, v206
    v_cvt_f32_i32 v207, v207
    v_pk_fma_f32 v[204:205], v[204:205], v[116:117], v[120:121]
    v_pk_fma_f32 v[206:207], v[206:207], v[118:119], v[122:123]
    v_cvt_pk_bf16_f32 v204, v204, v205
    v_cvt_pk_bf16_f32 v205, v206, v207
    ds_write_b64 v131, v[204:205] offset:1728
    s_waitcnt vmcnt(16)
    v_cvt_f32_i32 v208, v208
    v_cvt_f32_i32 v209, v209
    v_cvt_f32_i32 v210, v210
    v_cvt_f32_i32 v211, v211
    v_pk_fma_f32 v[208:209], v[208:209], v[116:117], v[120:121]
    v_pk_fma_f32 v[210:211], v[210:211], v[118:119], v[122:123]
    v_cvt_pk_bf16_f32 v208, v208, v209
    v_cvt_pk_bf16_f32 v209, v210, v211
    ds_write_b64 v131, v[208:209] offset:2304
    v_cvt_f32_i32 v212, v212
    v_cvt_f32_i32 v213, v213
    v_cvt_f32_i32 v214, v214
    v_cvt_f32_i32 v215, v215
    v_pk_fma_f32 v[212:213], v[212:213], v[116:117], v[120:121]
    v_pk_fma_f32 v[214:215], v[214:215], v[118:119], v[122:123]
    v_cvt_pk_bf16_f32 v212, v212, v213
    v_cvt_pk_bf16_f32 v213, v214, v215
    ds_write_b64 v131, v[212:213] offset:2880
    v_cvt_f32_i32 v216, v216
    v_cvt_f32_i32 v217, v217
    v_cvt_f32_i32 v218, v218
    v_cvt_f32_i32 v219, v219
    v_pk_fma_f32 v[216:217], v[216:217], v[116:117], v[120:121]
    v_pk_fma_f32 v[218:219], v[218:219], v[118:119], v[122:123]
    v_cvt_pk_bf16_f32 v216, v216, v217
    v_cvt_pk_bf16_f32 v217, v218, v219
    ds_write_b64 v131, v[216:217] offset:3456
    v_cvt_f32_i32 v220, v220
    v_cvt_f32_i32 v221, v221
    v_cvt_f32_i32 v222, v222
    v_cvt_f32_i32 v223, v223
    v_pk_fma_f32 v[220:221], v[220:221], v[116:117], v[120:121]
    v_pk_fma_f32 v[222:223], v[222:223], v[118:119], v[122:123]
    v_cvt_pk_bf16_f32 v220, v220, v221
    v_cvt_pk_bf16_f32 v221, v222, v223
    ds_write_b64 v131, v[220:221] offset:4032
    ds_read_b128 v[100:103], v132 offset:0
    ds_read_b128 v[104:107], v132 offset:64
    ds_read_b128 v[108:111], v132 offset:128
    ds_read_b128 v[112:115], v132 offset:192
    s_add_u32 s6, s4, 0xc08000
    s_waitcnt vmcnt(1)
    buffer_load_dwordx4 v[192:195], v128, s[36:39], s6 offen offset:0 nt
    buffer_load_dwordx4 v[196:199], v128, s[36:39], s6 offen offset:1024 nt
    buffer_load_dwordx4 v[200:203], v128, s[36:39], s6 offen offset:2048 nt
    buffer_load_dwordx4 v[204:207], v128, s[36:39], s6 offen offset:3072 nt
    buffer_load_dwordx4 v[208:211], v129, s[36:39], s6 offen offset:0 nt
    buffer_load_dwordx4 v[212:215], v129, s[36:39], s6 offen offset:1024 nt
    buffer_load_dwordx4 v[216:219], v129, s[36:39], s6 offen offset:2048 nt
    buffer_load_dwordx4 v[220:223], v129, s[36:39], s6 offen offset:3072 nt
    s_waitcnt lgkmcnt(3)
    v_mfma_f32_16x16x32_bf16 v[72:75], v[100:103], v[0:3], 0
    s_waitcnt lgkmcnt(2)
    v_mfma_f32_16x16x32_bf16 v[72:75], v[104:107], v[4:7], v[72:75]
    s_waitcnt lgkmcnt(1)
    v_mfma_f32_16x16x32_bf16 v[72:75], v[108:111], v[8:11], v[72:75]
    s_waitcnt lgkmcnt(0)
    v_mfma_f32_16x16x32_bf16 v[72:75], v[112:115], v[12:15], v[72:75]
    v_max3_f32 v156, v156, v68, v69
    v_max3_f32 v157, v157, v70, v71
    s_waitcnt vmcnt(20)
    v_cvt_f32_i32 v224, v224
    v_cvt_f32_i32 v225, v225
    v_cvt_f32_i32 v226, v226
    v_cvt_f32_i32 v227, v227
    v_pk_fma_f32 v[224:225], v[224:225], v[116:117], v[120:121]
    v_pk_fma_f32 v[226:227], v[226:227], v[118:119], v[122:123]
    v_cvt_pk_bf16_f32 v224, v224, v225
    v_cvt_pk_bf16_f32 v225, v226, v227
    ds_write_b64 v131, v[224:225] offset:0
    v_cvt_f32_i32 v228, v228
    v_cvt_f32_i32 v229, v229
    v_cvt_f32_i32 v230, v230
    v_cvt_f32_i32 v231, v231
    v_pk_fma_f32 v[228:229], v[228:229], v[116:117], v[120:121]
    v_pk_fma_f32 v[230:231], v[230:231], v[118:119], v[122:123]
    v_cvt_pk_bf16_f32 v228, v228, v229
    v_cvt_pk_bf16_f32 v229, v230, v231
    ds_write_b64 v131, v[228:229] offset:576
    v_cvt_f32_i32 v232, v232
    v_cvt_f32_i32 v233, v233
    v_cvt_f32_i32 v234, v234
    v_cvt_f32_i32 v235, v235
    v_pk_fma_f32 v[232:233], v[232:233], v[116:117], v[120:121]
    v_pk_fma_f32 v[234:235], v[234:235], v[118:119], v[122:123]
    v_cvt_pk_bf16_f32 v232, v232, v233
    v_cvt_pk_bf16_f32 v233, v234, v235
    ds_write_b64 v131, v[232:233] offset:1152
    v_cvt_f32_i32 v236, v236
    v_cvt_f32_i32 v237, v237
    v_cvt_f32_i32 v238, v238
    v_cvt_f32_i32 v239, v239
    v_pk_fma_f32 v[236:237], v[236:237], v[116:117], v[120:121]
    v_pk_fma_f32 v[238:239], v[238:239], v[118:119], v[122:123]
    v_cvt_pk_bf16_f32 v236, v236, v237
    v_cvt_pk_bf16_f32 v237, v238, v239
    ds_write_b64 v131, v[236:237] offset:1728
    s_waitcnt vmcnt(16)
    v_cvt_f32_i32 v240, v240
    v_cvt_f32_i32 v241, v241
    v_cvt_f32_i32 v242, v242
    v_cvt_f32_i32 v243, v243
    v_pk_fma_f32 v[240:241], v[240:241], v[116:117], v[120:121]
    v_pk_fma_f32 v[242:243], v[242:243], v[118:119], v[122:123]
    v_cvt_pk_bf16_f32 v240, v240, v241
    v_cvt_pk_bf16_f32 v241, v242, v243
    ds_write_b64 v131, v[240:241] offset:2304
    v_cvt_f32_i32 v244, v244
    v_cvt_f32_i32 v245, v245
    v_cvt_f32_i32 v246, v246
    v_cvt_f32_i32 v247, v247
    v_pk_fma_f32 v[244:245], v[244:245], v[116:117], v[120:121]
    v_pk_fma_f32 v[246:247], v[246:247], v[118:119], v[122:123]
    v_cvt_pk_bf16_f32 v244, v244, v245
    v_cvt_pk_bf16_f32 v245, v246, v247
    ds_write_b64 v131, v[244:245] offset:2880
    v_cvt_f32_i32 v248, v248
    v_cvt_f32_i32 v249, v249
    v_cvt_f32_i32 v250, v250
    v_cvt_f32_i32 v251, v251
    v_pk_fma_f32 v[248:249], v[248:249], v[116:117], v[120:121]
    v_pk_fma_f32 v[250:251], v[250:251], v[118:119], v[122:123]
    v_cvt_pk_bf16_f32 v248, v248, v249
    v_cvt_pk_bf16_f32 v249, v250, v251
    ds_write_b64 v131, v[248:249] offset:3456
    v_cvt_f32_i32 v252, v252
    v_cvt_f32_i32 v253, v253
    v_cvt_f32_i32 v254, v254
    v_cvt_f32_i32 v255, v255
    v_pk_fma_f32 v[252:253], v[252:253], v[116:117], v[120:121]
    v_pk_fma_f32 v[254:255], v[254:255], v[118:119], v[122:123]
    v_cvt_pk_bf16_f32 v252, v252, v253
    v_cvt_pk_bf16_f32 v253, v254, v255
    ds_write_b64 v131, v[252:253] offset:4032
    ds_read_b128 v[100:103], v132 offset:0
    ds_read_b128 v[104:107], v132 offset:64
    ds_read_b128 v[108:111], v132 offset:128
    ds_read_b128 v[112:115], v132 offset:192
    ds_read_b64 v[124:125], v134 offset:19968
    ds_read_b64 v[126:127], v134 offset:22016
    s_add_u32 s5, s4, 0xc10000
    s_waitcnt vmcnt(1)
    buffer_load_dwordx4 v[224:227], v128, s[36:39], s5 offen offset:0 nt
    buffer_load_dwordx4 v[228:231], v128, s[36:39], s5 offen offset:1024 nt
    buffer_load_dwordx4 v[232:235], v128, s[36:39], s5 offen offset:2048 nt
    buffer_load_dwordx4 v[236:239], v128, s[36:39], s5 offen offset:3072 nt
    buffer_load_dwordx4 v[240:243], v129, s[36:39], s5 offen offset:0 nt
    buffer_load_dwordx4 v[244:247], v129, s[36:39], s5 offen offset:1024 nt
    buffer_load_dwordx4 v[248:251], v129, s[36:39], s5 offen offset:2048 nt
    buffer_load_dwordx4 v[252:255], v129, s[36:39], s5 offen offset:3072 nt
    s_waitcnt lgkmcnt(5)
    v_mfma_f32_16x16x32_bf16 v[76:79], v[100:103], v[0:3], 0
    s_waitcnt lgkmcnt(4)
    v_mfma_f32_16x16x32_bf16 v[76:79], v[104:107], v[4:7], v[76:79]
    s_waitcnt lgkmcnt(3)
    v_mfma_f32_16x16x32_bf16 v[76:79], v[108:111], v[8:11], v[76:79]
    s_waitcnt lgkmcnt(2)
    v_mfma_f32_16x16x32_bf16 v[76:79], v[112:115], v[12:15], v[76:79]
    s_waitcnt lgkmcnt(0)
    v_lshlrev_b32 v116, 16, v124
    v_and_b32 v117, s14, v124
    v_lshlrev_b32 v118, 16, v125
    v_and_b32 v119, s14, v125
    v_lshlrev_b32 v120, 16, v126
    v_and_b32 v121, s14, v126
    v_lshlrev_b32 v122, 16, v127
    v_and_b32 v123, s14, v127
    v_mul_f32 v120, -v120, v116
    v_mul_f32 v121, -v121, v117
    v_mul_f32 v122, -v122, v118
    v_mul_f32 v123, -v123, v119
    v_max3_f32 v156, v156, v72, v73
    v_max3_f32 v157, v157, v74, v75
    s_waitcnt vmcnt(20)
    v_cvt_f32_i32 v160, v160
    v_cvt_f32_i32 v161, v161
    v_cvt_f32_i32 v162, v162
    v_cvt_f32_i32 v163, v163
    v_pk_fma_f32 v[160:161], v[160:161], v[116:117], v[120:121]
    v_pk_fma_f32 v[162:163], v[162:163], v[118:119], v[122:123]
    v_cvt_pk_bf16_f32 v160, v160, v161
    v_cvt_pk_bf16_f32 v161, v162, v163
    ds_write_b64 v131, v[160:161] offset:0
    v_cvt_f32_i32 v164, v164
    v_cvt_f32_i32 v165, v165
    v_cvt_f32_i32 v166, v166
    v_cvt_f32_i32 v167, v167
    v_pk_fma_f32 v[164:165], v[164:165], v[116:117], v[120:121]
    v_pk_fma_f32 v[166:167], v[166:167], v[118:119], v[122:123]
    v_cvt_pk_bf16_f32 v164, v164, v165
    v_cvt_pk_bf16_f32 v165, v166, v167
    ds_write_b64 v131, v[164:165] offset:576
    v_cvt_f32_i32 v168, v168
    v_cvt_f32_i32 v169, v169
    v_cvt_f32_i32 v170, v170
    v_cvt_f32_i32 v171, v171
    v_pk_fma_f32 v[168:169], v[168:169], v[116:117], v[120:121]
    v_pk_fma_f32 v[170:171], v[170:171], v[118:119], v[122:123]
    v_cvt_pk_bf16_f32 v168, v168, v169
    v_cvt_pk_bf16_f32 v169, v170, v171
    ds_write_b64 v131, v[168:169] offset:1152
    v_cvt_f32_i32 v172, v172
    v_cvt_f32_i32 v173, v173
    v_cvt_f32_i32 v174, v174
    v_cvt_f32_i32 v175, v175
    v_pk_fma_f32 v[172:173], v[172:173], v[116:117], v[120:121]
    v_pk_fma_f32 v[174:175], v[174:175], v[118:119], v[122:123]
    v_cvt_pk_bf16_f32 v172, v172, v173
    v_cvt_pk_bf16_f32 v173, v174, v175
    ds_write_b64 v131, v[172:173] offset:1728
    s_waitcnt vmcnt(16)
    v_cvt_f32_i32 v176, v176
    v_cvt_f32_i32 v177, v177
    v_cvt_f32_i32 v178, v178
    v_cvt_f32_i32 v179, v179
    v_pk_fma_f32 v[176:177], v[176:177], v[116:117], v[120:121]
    v_pk_fma_f32 v[178:179], v[178:179], v[118:119], v[122:123]
    v_cvt_pk_bf16_f32 v176, v176, v177
    v_cvt_pk_bf16_f32 v177, v178, v179
    ds_write_b64 v131, v[176:177] offset:2304
    v_cvt_f32_i32 v180, v180
    v_cvt_f32_i32 v181, v181
    v_cvt_f32_i32 v182, v182
    v_cvt_f32_i32 v183, v183
    v_pk_fma_f32 v[180:181], v[180:181], v[116:117], v[120:121]
    v_pk_fma_f32 v[182:183], v[182:183], v[118:119], v[122:123]
    v_cvt_pk_bf16_f32 v180, v180, v181
    v_cvt_pk_bf16_f32 v181, v182, v183
    ds_write_b64 v131, v[180:181] offset:2880
    v_cvt_f32_i32 v184, v184
    v_cvt_f32_i32 v185, v185
    v_cvt_f32_i32 v186, v186
    v_cvt_f32_i32 v187, v187
    v_pk_fma_f32 v[184:185], v[184:185], v[116:117], v[120:121]
    v_pk_fma_f32 v[186:187], v[186:187], v[118:119], v[122:123]
    v_cvt_pk_bf16_f32 v184, v184, v185
    v_cvt_pk_bf16_f32 v185, v186, v187
    ds_write_b64 v131, v[184:185] offset:3456
    v_cvt_f32_i32 v188, v188
    v_cvt_f32_i32 v189, v189
    v_cvt_f32_i32 v190, v190
    v_cvt_f32_i32 v191, v191
    v_pk_fma_f32 v[188:189], v[188:189], v[116:117], v[120:121]
    v_pk_fma_f32 v[190:191], v[190:191], v[118:119], v[122:123]
    v_cvt_pk_bf16_f32 v188, v188, v189
    v_cvt_pk_bf16_f32 v189, v190, v191
    ds_write_b64 v131, v[188:189] offset:4032
    ds_read_b128 v[100:103], v132 offset:0
    ds_read_b128 v[104:107], v132 offset:64
    ds_read_b128 v[108:111], v132 offset:128
    ds_read_b128 v[112:115], v132 offset:192
    s_add_u32 s6, s4, 0xc18000
    s_waitcnt vmcnt(1)
    buffer_load_dwordx4 v[160:163], v128, s[36:39], s6 offen offset:0 nt
    buffer_load_dwordx4 v[164:167], v128, s[36:39], s6 offen offset:1024 nt
    buffer_load_dwordx4 v[168:171], v128, s[36:39], s6 offen offset:2048 nt
    buffer_load_dwordx4 v[172:175], v128, s[36:39], s6 offen offset:3072 nt
    buffer_load_dwordx4 v[176:179], v129, s[36:39], s6 offen offset:0 nt
    buffer_load_dwordx4 v[180:183], v129, s[36:39], s6 offen offset:1024 nt
    buffer_load_dwordx4 v[184:187], v129, s[36:39], s6 offen offset:2048 nt
    buffer_load_dwordx4 v[188:191], v129, s[36:39], s6 offen offset:3072 nt
    s_waitcnt lgkmcnt(3)
    v_mfma_f32_16x16x32_bf16 v[80:83], v[100:103], v[0:3], 0
    s_waitcnt lgkmcnt(2)
    v_mfma_f32_16x16x32_bf16 v[80:83], v[104:107], v[4:7], v[80:83]
    s_waitcnt lgkmcnt(1)
    v_mfma_f32_16x16x32_bf16 v[80:83], v[108:111], v[8:11], v[80:83]
    s_waitcnt lgkmcnt(0)
    v_mfma_f32_16x16x32_bf16 v[80:83], v[112:115], v[12:15], v[80:83]
    v_max3_f32 v156, v156, v76, v77
    v_max3_f32 v157, v157, v78, v79
    s_waitcnt vmcnt(20)
    v_cvt_f32_i32 v192, v192
    v_cvt_f32_i32 v193, v193
    v_cvt_f32_i32 v194, v194
    v_cvt_f32_i32 v195, v195
    v_pk_fma_f32 v[192:193], v[192:193], v[116:117], v[120:121]
    v_pk_fma_f32 v[194:195], v[194:195], v[118:119], v[122:123]
    v_cvt_pk_bf16_f32 v192, v192, v193
    v_cvt_pk_bf16_f32 v193, v194, v195
    ds_write_b64 v131, v[192:193] offset:0
    v_cvt_f32_i32 v196, v196
    v_cvt_f32_i32 v197, v197
    v_cvt_f32_i32 v198, v198
    v_cvt_f32_i32 v199, v199
    v_pk_fma_f32 v[196:197], v[196:197], v[116:117], v[120:121]
    v_pk_fma_f32 v[198:199], v[198:199], v[118:119], v[122:123]
    v_cvt_pk_bf16_f32 v196, v196, v197
    v_cvt_pk_bf16_f32 v197, v198, v199
    ds_write_b64 v131, v[196:197] offset:576
    v_cvt_f32_i32 v200, v200
    v_cvt_f32_i32 v201, v201
    v_cvt_f32_i32 v202, v202
    v_cvt_f32_i32 v203, v203
    v_pk_fma_f32 v[200:201], v[200:201], v[116:117], v[120:121]
    v_pk_fma_f32 v[202:203], v[202:203], v[118:119], v[122:123]
    v_cvt_pk_bf16_f32 v200, v200, v201
    v_cvt_pk_bf16_f32 v201, v202, v203
    ds_write_b64 v131, v[200:201] offset:1152
    v_cvt_f32_i32 v204, v204
    v_cvt_f32_i32 v205, v205
    v_cvt_f32_i32 v206, v206
    v_cvt_f32_i32 v207, v207
    v_pk_fma_f32 v[204:205], v[204:205], v[116:117], v[120:121]
    v_pk_fma_f32 v[206:207], v[206:207], v[118:119], v[122:123]
    v_cvt_pk_bf16_f32 v204, v204, v205
    v_cvt_pk_bf16_f32 v205, v206, v207
    ds_write_b64 v131, v[204:205] offset:1728
    s_waitcnt vmcnt(16)
    v_cvt_f32_i32 v208, v208
    v_cvt_f32_i32 v209, v209
    v_cvt_f32_i32 v210, v210
    v_cvt_f32_i32 v211, v211
    v_pk_fma_f32 v[208:209], v[208:209], v[116:117], v[120:121]
    v_pk_fma_f32 v[210:211], v[210:211], v[118:119], v[122:123]
    v_cvt_pk_bf16_f32 v208, v208, v209
    v_cvt_pk_bf16_f32 v209, v210, v211
    ds_write_b64 v131, v[208:209] offset:2304
    v_cvt_f32_i32 v212, v212
    v_cvt_f32_i32 v213, v213
    v_cvt_f32_i32 v214, v214
    v_cvt_f32_i32 v215, v215
    v_pk_fma_f32 v[212:213], v[212:213], v[116:117], v[120:121]
    v_pk_fma_f32 v[214:215], v[214:215], v[118:119], v[122:123]
    v_cvt_pk_bf16_f32 v212, v212, v213
    v_cvt_pk_bf16_f32 v213, v214, v215
    ds_write_b64 v131, v[212:213] offset:2880
    v_cvt_f32_i32 v216, v216
    v_cvt_f32_i32 v217, v217
    v_cvt_f32_i32 v218, v218
    v_cvt_f32_i32 v219, v219
    v_pk_fma_f32 v[216:217], v[216:217], v[116:117], v[120:121]
    v_pk_fma_f32 v[218:219], v[218:219], v[118:119], v[122:123]
    v_cvt_pk_bf16_f32 v216, v216, v217
    v_cvt_pk_bf16_f32 v217, v218, v219
    ds_write_b64 v131, v[216:217] offset:3456
    v_cvt_f32_i32 v220, v220
    v_cvt_f32_i32 v221, v221
    v_cvt_f32_i32 v222, v222
    v_cvt_f32_i32 v223, v223
    v_pk_fma_f32 v[220:221], v[220:221], v[116:117], v[120:121]
    v_pk_fma_f32 v[222:223], v[222:223], v[118:119], v[122:123]
    v_cvt_pk_bf16_f32 v220, v220, v221
    v_cvt_pk_bf16_f32 v221, v222, v223
    ds_write_b64 v131, v[220:221] offset:4032
    ds_read_b128 v[100:103], v132 offset:0
    ds_read_b128 v[104:107], v132 offset:64
    ds_read_b128 v[108:111], v132 offset:128
    ds_read_b128 v[112:115], v132 offset:192
    ds_read_b64 v[124:125], v134 offset:20224
    ds_read_b64 v[126:127], v134 offset:22272
    s_waitcnt vmcnt(1)
    buffer_load_dwordx4 v[192:195], v130, s[40:43], s4 offen offset:0 nt
    buffer_load_dwordx4 v[196:199], v130, s[40:43], s4 offen offset:512 nt
    buffer_load_dwordx4 v[200:203], v130, s[40:43], s4 offen offset:1024 nt
    buffer_load_dwordx4 v[204:207], v130, s[40:43], s4 offen offset:1536 nt
    buffer_load_dwordx4 v[208:211], v130, s[40:43], s4 offen offset:256 nt
    buffer_load_dwordx4 v[212:215], v130, s[40:43], s4 offen offset:768 nt
    buffer_load_dwordx4 v[216:219], v130, s[40:43], s4 offen offset:1280 nt
    buffer_load_dwordx4 v[220:223], v130, s[40:43], s4 offen offset:1792 nt
    s_waitcnt lgkmcnt(5)
    v_mfma_f32_16x16x32_bf16 v[84:87], v[100:103], v[0:3], 0
    s_waitcnt lgkmcnt(4)
    v_mfma_f32_16x16x32_bf16 v[84:87], v[104:107], v[4:7], v[84:87]
    s_waitcnt lgkmcnt(3)
    v_mfma_f32_16x16x32_bf16 v[84:87], v[108:111], v[8:11], v[84:87]
    s_waitcnt lgkmcnt(2)
    v_mfma_f32_16x16x32_bf16 v[84:87], v[112:115], v[12:15], v[84:87]
    s_waitcnt lgkmcnt(0)
    v_lshlrev_b32 v116, 16, v124
    v_and_b32 v117, s14, v124
    v_lshlrev_b32 v118, 16, v125
    v_and_b32 v119, s14, v125
    v_lshlrev_b32 v120, 16, v126
    v_and_b32 v121, s14, v126
    v_lshlrev_b32 v122, 16, v127
    v_and_b32 v123, s14, v127
    v_mul_f32 v120, -v120, v116
    v_mul_f32 v121, -v121, v117
    v_mul_f32 v122, -v122, v118
    v_mul_f32 v123, -v123, v119
    v_max3_f32 v156, v156, v80, v81
    v_max3_f32 v157, v157, v82, v83
    s_waitcnt vmcnt(20)
    v_cvt_f32_i32 v224, v224
    v_cvt_f32_i32 v225, v225
    v_cvt_f32_i32 v226, v226
    v_cvt_f32_i32 v227, v227
    v_pk_fma_f32 v[224:225], v[224:225], v[116:117], v[120:121]
    v_pk_fma_f32 v[226:227], v[226:227], v[118:119], v[122:123]
    v_cvt_pk_bf16_f32 v224, v224, v225
    v_cvt_pk_bf16_f32 v225, v226, v227
    ds_write_b64 v131, v[224:225] offset:0
    v_cvt_f32_i32 v228, v228
    v_cvt_f32_i32 v229, v229
    v_cvt_f32_i32 v230, v230
    v_cvt_f32_i32 v231, v231
    v_pk_fma_f32 v[228:229], v[228:229], v[116:117], v[120:121]
    v_pk_fma_f32 v[230:231], v[230:231], v[118:119], v[122:123]
    v_cvt_pk_bf16_f32 v228, v228, v229
    v_cvt_pk_bf16_f32 v229, v230, v231
    ds_write_b64 v131, v[228:229] offset:576
    v_cvt_f32_i32 v232, v232
    v_cvt_f32_i32 v233, v233
    v_cvt_f32_i32 v234, v234
    v_cvt_f32_i32 v235, v235
    v_pk_fma_f32 v[232:233], v[232:233], v[116:117], v[120:121]
    v_pk_fma_f32 v[234:235], v[234:235], v[118:119], v[122:123]
    v_cvt_pk_bf16_f32 v232, v232, v233
    v_cvt_pk_bf16_f32 v233, v234, v235
    ds_write_b64 v131, v[232:233] offset:1152
    v_cvt_f32_i32 v236, v236
    v_cvt_f32_i32 v237, v237
    v_cvt_f32_i32 v238, v238
    v_cvt_f32_i32 v239, v239
    v_pk_fma_f32 v[236:237], v[236:237], v[116:117], v[120:121]
    v_pk_fma_f32 v[238:239], v[238:239], v[118:119], v[122:123]
    v_cvt_pk_bf16_f32 v236, v236, v237
    v_cvt_pk_bf16_f32 v237, v238, v239
    ds_write_b64 v131, v[236:237] offset:1728
    s_waitcnt vmcnt(16)
    v_cvt_f32_i32 v240, v240
    v_cvt_f32_i32 v241, v241
    v_cvt_f32_i32 v242, v242
    v_cvt_f32_i32 v243, v243
    v_pk_fma_f32 v[240:241], v[240:241], v[116:117], v[120:121]
    v_pk_fma_f32 v[242:243], v[242:243], v[118:119], v[122:123]
    v_cvt_pk_bf16_f32 v240, v240, v241
    v_cvt_pk_bf16_f32 v241, v242, v243
    ds_write_b64 v131, v[240:241] offset:2304
    v_cvt_f32_i32 v244, v244
    v_cvt_f32_i32 v245, v245
    v_cvt_f32_i32 v246, v246
    v_cvt_f32_i32 v247, v247
    v_pk_fma_f32 v[244:245], v[244:245], v[116:117], v[120:121]
    v_pk_fma_f32 v[246:247], v[246:247], v[118:119], v[122:123]
    v_cvt_pk_bf16_f32 v244, v244, v245
    v_cvt_pk_bf16_f32 v245, v246, v247
    ds_write_b64 v131, v[244:245] offset:2880
    v_cvt_f32_i32 v248, v248
    v_cvt_f32_i32 v249, v249
    v_cvt_f32_i32 v250, v250
    v_cvt_f32_i32 v251, v251
    v_pk_fma_f32 v[248:249], v[248:249], v[116:117], v[120:121]
    v_pk_fma_f32 v[250:251], v[250:251], v[118:119], v[122:123]
    v_cvt_pk_bf16_f32 v248, v248, v249
    v_cvt_pk_bf16_f32 v249, v250, v251
    ds_write_b64 v131, v[248:249] offset:3456
    v_cvt_f32_i32 v252, v252
    v_cvt_f32_i32 v253, v253
    v_cvt_f32_i32 v254, v254
    v_cvt_f32_i32 v255, v255
    v_pk_fma_f32 v[252:253], v[252:253], v[116:117], v[120:121]
    v_pk_fma_f32 v[254:255], v[254:255], v[118:119], v[122:123]
    v_cvt_pk_bf16_f32 v252, v252, v253
    v_cvt_pk_bf16_f32 v253, v254, v255
    ds_write_b64 v131, v[252:253] offset:4032
    ds_read_b128 v[100:103], v132 offset:0
    ds_read_b128 v[104:107], v132 offset:64
    ds_read_b128 v[108:111], v132 offset:128
    ds_read_b128 v[112:115], v132 offset:192
    s_add_u32 s6, s4, 0x8000
    s_waitcnt vmcnt(1)
    buffer_load_dwordx4 v[224:227], v130, s[40:43], s6 offen offset:0 nt
    buffer_load_dwordx4 v[228:231], v130, s[40:43], s6 offen offset:512 nt
    buffer_load_dwordx4 v[232:235], v130, s[40:43], s6 offen offset:1024 nt
    buffer_load_dwordx4 v[236:239], v130, s[40:43], s6 offen offset:1536 nt
    buffer_load_dwordx4 v[240:243], v130, s[40:43], s6 offen offset:256 nt
    buffer_load_dwordx4 v[244:247], v130, s[40:43], s6 offen offset:768 nt
    buffer_load_dwordx4 v[248:251], v130, s[40:43], s6 offen offset:1280 nt
    buffer_load_dwordx4 v[252:255], v130, s[40:43], s6 offen offset:1792 nt
    s_waitcnt lgkmcnt(3)
    v_mfma_f32_16x16x32_bf16 v[88:91], v[100:103], v[0:3], 0
    s_waitcnt lgkmcnt(2)
    v_mfma_f32_16x16x32_bf16 v[88:91], v[104:107], v[4:7], v[88:91]
    s_waitcnt lgkmcnt(1)
    v_mfma_f32_16x16x32_bf16 v[88:91], v[108:111], v[8:11], v[88:91]
    s_waitcnt lgkmcnt(0)
    v_mfma_f32_16x16x32_bf16 v[88:91], v[112:115], v[12:15], v[88:91]
    v_max3_f32 v156, v156, v84, v85
    v_max3_f32 v157, v157, v86, v87
    s_waitcnt vmcnt(20)
    v_cvt_f32_i32 v160, v160
    v_cvt_f32_i32 v161, v161
    v_cvt_f32_i32 v162, v162
    v_cvt_f32_i32 v163, v163
    v_pk_fma_f32 v[160:161], v[160:161], v[116:117], v[120:121]
    v_pk_fma_f32 v[162:163], v[162:163], v[118:119], v[122:123]
    v_cvt_pk_bf16_f32 v160, v160, v161
    v_cvt_pk_bf16_f32 v161, v162, v163
    ds_write_b64 v131, v[160:161] offset:0
    v_cvt_f32_i32 v164, v164
    v_cvt_f32_i32 v165, v165
    v_cvt_f32_i32 v166, v166
    v_cvt_f32_i32 v167, v167
    v_pk_fma_f32 v[164:165], v[164:165], v[116:117], v[120:121]
    v_pk_fma_f32 v[166:167], v[166:167], v[118:119], v[122:123]
    v_cvt_pk_bf16_f32 v164, v164, v165
    v_cvt_pk_bf16_f32 v165, v166, v167
    ds_write_b64 v131, v[164:165] offset:576
    v_cvt_f32_i32 v168, v168
    v_cvt_f32_i32 v169, v169
    v_cvt_f32_i32 v170, v170
    v_cvt_f32_i32 v171, v171
    v_pk_fma_f32 v[168:169], v[168:169], v[116:117], v[120:121]
    v_pk_fma_f32 v[170:171], v[170:171], v[118:119], v[122:123]
    v_cvt_pk_bf16_f32 v168, v168, v169
    v_cvt_pk_bf16_f32 v169, v170, v171
    ds_write_b64 v131, v[168:169] offset:1152
    v_cvt_f32_i32 v172, v172
    v_cvt_f32_i32 v173, v173
    v_cvt_f32_i32 v174, v174
    v_cvt_f32_i32 v175, v175
    v_pk_fma_f32 v[172:173], v[172:173], v[116:117], v[120:121]
    v_pk_fma_f32 v[174:175], v[174:175], v[118:119], v[122:123]
    v_cvt_pk_bf16_f32 v172, v172, v173
    v_cvt_pk_bf16_f32 v173, v174, v175
    ds_write_b64 v131, v[172:173] offset:1728
    s_waitcnt vmcnt(16)
    v_cvt_f32_i32 v176, v176
    v_cvt_f32_i32 v177, v177
    v_cvt_f32_i32 v178, v178
    v_cvt_f32_i32 v179, v179
    v_pk_fma_f32 v[176:177], v[176:177], v[116:117], v[120:121]
    v_pk_fma_f32 v[178:179], v[178:179], v[118:119], v[122:123]
    v_cvt_pk_bf16_f32 v176, v176, v177
    v_cvt_pk_bf16_f32 v177, v178, v179
    ds_write_b64 v131, v[176:177] offset:2304
    v_cvt_f32_i32 v180, v180
    v_cvt_f32_i32 v181, v181
    v_cvt_f32_i32 v182, v182
    v_cvt_f32_i32 v183, v183
    v_pk_fma_f32 v[180:181], v[180:181], v[116:117], v[120:121]
    v_pk_fma_f32 v[182:183], v[182:183], v[118:119], v[122:123]
    v_cvt_pk_bf16_f32 v180, v180, v181
    v_cvt_pk_bf16_f32 v181, v182, v183
    ds_write_b64 v131, v[180:181] offset:2880
    v_cvt_f32_i32 v184, v184
    v_cvt_f32_i32 v185, v185
    v_cvt_f32_i32 v186, v186
    v_cvt_f32_i32 v187, v187
    v_pk_fma_f32 v[184:185], v[184:185], v[116:117], v[120:121]
    v_pk_fma_f32 v[186:187], v[186:187], v[118:119], v[122:123]
    v_cvt_pk_bf16_f32 v184, v184, v185
    v_cvt_pk_bf16_f32 v185, v186, v187
    ds_write_b64 v131, v[184:185] offset:3456
    v_cvt_f32_i32 v188, v188
    v_cvt_f32_i32 v189, v189
    v_cvt_f32_i32 v190, v190
    v_cvt_f32_i32 v191, v191
    v_pk_fma_f32 v[188:189], v[188:189], v[116:117], v[120:121]
    v_pk_fma_f32 v[190:191], v[190:191], v[118:119], v[122:123]
    v_cvt_pk_bf16_f32 v188, v188, v189
    v_cvt_pk_bf16_f32 v189, v190, v191
    ds_write_b64 v131, v[188:189] offset:4032
    ds_read_b128 v[100:103], v132 offset:0
    ds_read_b128 v[104:107], v132 offset:64
    ds_read_b128 v[108:111], v132 offset:128
    ds_read_b128 v[112:115], v132 offset:192
    ds_read_b64 v[148:149], v135 offset:22528
    ds_read_b64 v[150:151], v135 offset:24576
    s_add_u32 s5, s4, 0x10000
    s_waitcnt vmcnt(1)
    buffer_load_dwordx4 v[160:163], v130, s[40:43], s5 offen offset:0 nt
    buffer_load_dwordx4 v[164:167], v130, s[40:43], s5 offen offset:512 nt
    buffer_load_dwordx4 v[168:171], v130, s[40:43], s5 offen offset:1024 nt
    buffer_load_dwordx4 v[172:175], v130, s[40:43], s5 offen offset:1536 nt
    buffer_load_dwordx4 v[176:179], v130, s[40:43], s5 offen offset:256 nt
    buffer_load_dwordx4 v[180:183], v130, s[40:43], s5 offen offset:768 nt
    buffer_load_dwordx4 v[184:187], v130, s[40:43], s5 offen offset:1280 nt
    buffer_load_dwordx4 v[188:191], v130, s[40:43], s5 offen offset:1792 nt
    s_waitcnt lgkmcnt(5)
    v_mfma_f32_16x16x32_bf16 v[92:95], v[100:103], v[0:3], 0
    s_waitcnt lgkmcnt(4)
    v_mfma_f32_16x16x32_bf16 v[92:95], v[104:107], v[4:7], v[92:95]
    s_waitcnt lgkmcnt(3)
    v_mfma_f32_16x16x32_bf16 v[92:95], v[108:111], v[8:11], v[92:95]
    s_waitcnt lgkmcnt(2)
    v_mfma_f32_16x16x32_bf16 v[92:95], v[112:115], v[12:15], v[92:95]
    v_max3_f32 v156, v156, v88, v89
    v_max3_f32 v157, v157, v90, v91
    v_mbcnt_lo_u32_b32 v116, -1, 0
    v_mbcnt_hi_u32_b32 v116, -1, v116
    v_and_b32 v122, 7, v116
    v_mul_u32_u24 v117, 528, v122
    v_bfe_u32 v118, v116, 3, 1
    v_lshl_add_u32 v117, v118, 8, v117
    v_lshrrev_b32 v118, 4, v116
    v_lshl_add_u32 v117, v118, 6, v117
    v_max3_f32 v156, v156, v92, v93
    v_max3_f32 v157, v157, v94, v95
    v_max_f32 v156, v156, v157
    v_mov_b32 v157, v156
    s_nop 1
    v_permlane32_swap_b32 v156, v157
    s_nop 1
    v_max_f32 v156, v156, v157
    v_mov_b32 v157, v156
    s_nop 1
    v_permlane16_swap_b32 v156, v157
    s_nop 1
    v_max_f32 v156, v156, v157
    v_mul_f32 v123, s13, v156
    v_fma_f32 v32, v32, s13, -v123
    v_fma_f32 v33, v33, s13, -v123
    v_fma_f32 v34, v34, s13, -v123
    v_fma_f32 v35, v35, s13, -v123
    v_exp_f32 v32, v32
    v_exp_f32 v33, v33
    v_exp_f32 v34, v34
    v_exp_f32 v35, v35
    s_waitcnt lgkmcnt(0)
    v_lshlrev_b32 v124, 16, v148
    v_and_b32 v125, s14, v148
    v_lshlrev_b32 v126, 16, v149
    v_and_b32 v127, s14, v149
    ds_read_b64 v[152:153], v135 offset:22656
    ds_read_b64 v[154:155], v135 offset:24704
    v_add_f32 v156, v32, v33
    v_add_f32 v157, v34, v35
    v_mul_f32 v32, v32, v124
    v_mul_f32 v33, v33, v125
    v_mul_f32 v34, v34, v126
    v_mul_f32 v35, v35, v127
    v_add_f32 v158, v156, v157
    v_and_b32 v124, v133, v32
    v_and_b32 v125, v133, v33
    v_and_b32 v126, v133, v34
    v_and_b32 v127, v133, v35
    v_sub_f32 v32, v32, v124
    v_sub_f32 v33, v33, v125
    v_sub_f32 v34, v34, v126
    v_sub_f32 v35, v35, v127
    v_perm_b32 v144, v33, v32, s12
    v_perm_b32 v145, v35, v34, s12
    s_nop 1
    v_mfma_f32_16x16x16_bf16 v[96:99], v[150:151], v[144:145], 0
    v_fma_f32 v36, v36, s13, -v123
    v_fma_f32 v37, v37, s13, -v123
    v_fma_f32 v38, v38, s13, -v123
    v_fma_f32 v39, v39, s13, -v123
    v_exp_f32 v36, v36
    v_exp_f32 v37, v37
    v_exp_f32 v38, v38
    v_exp_f32 v39, v39
    s_waitcnt lgkmcnt(0)
    v_lshlrev_b32 v124, 16, v152
    v_and_b32 v125, s14, v152
    v_lshlrev_b32 v126, 16, v153
    v_and_b32 v127, s14, v153
    ds_read_b64 v[148:149], v135 offset:22784
    ds_read_b64 v[150:151], v135 offset:24832
    v_add_f32 v156, v36, v37
    v_add_f32 v157, v38, v39
    v_mul_f32 v36, v36, v124
    v_mul_f32 v37, v37, v125
    v_mul_f32 v38, v38, v126
    v_mul_f32 v39, v39, v127
    v_add_f32 v156, v156, v157
    v_and_b32 v124, v133, v36
    v_and_b32 v125, v133, v37
    v_and_b32 v126, v133, v38
    v_and_b32 v127, v133, v39
    v_add_f32 v158, v158, v156
    v_sub_f32 v36, v36, v124
    v_sub_f32 v37, v37, v125
    v_sub_f32 v38, v38, v126
    v_sub_f32 v39, v39, v127
    v_perm_b32 v146, v37, v36, s12
    v_perm_b32 v147, v39, v38, s12
    s_nop 1
    v_mfma_f32_16x16x16_bf16 v[96:99], v[154:155], v[146:147], v[96:99]
    s_waitcnt vmcnt(20)
    v_cvt_f32_i32 v192, v192
    v_cvt_f32_i32 v193, v193
    v_cvt_f32_i32 v194, v194
    v_cvt_f32_i32 v195, v195
    v_cvt_f32_i32 v196, v196
    v_cvt_f32_i32 v197, v197
    v_cvt_f32_i32 v198, v198
    v_cvt_f32_i32 v199, v199
    v_cvt_f32_i32 v200, v200
    v_cvt_f32_i32 v201, v201
    v_cvt_f32_i32 v202, v202
    v_cvt_f32_i32 v203, v203
    v_cvt_f32_i32 v204, v204
    v_cvt_f32_i32 v205, v205
    v_cvt_f32_i32 v206, v206
    v_cvt_f32_i32 v207, v207
    v_cvt_pk_bf16_f32 v100, v192, v196
    v_cvt_pk_bf16_f32 v101, v200, v204
    v_cvt_pk_bf16_f32 v102, v193, v197
    v_cvt_pk_bf16_f32 v103, v201, v205
    v_cvt_pk_bf16_f32 v104, v194, v198
    v_cvt_pk_bf16_f32 v105, v202, v206
    v_cvt_pk_bf16_f32 v106, v195, v199
    v_cvt_pk_bf16_f32 v107, v203, v207
    v_mfma_f32_16x16x16_bf16 v[0:3], v[100:101], v[144:145], 0
    v_mfma_f32_16x16x16_bf16 v[4:7], v[102:103], v[144:145], 0
    v_mfma_f32_16x16x16_bf16 v[8:11], v[104:105], v[144:145], 0
    v_mfma_f32_16x16x16_bf16 v[12:15], v[106:107], v[144:145], 0
    s_waitcnt vmcnt(16)
    v_cvt_f32_i32 v208, v208
    v_cvt_f32_i32 v209, v209
    v_cvt_f32_i32 v210, v210
    v_cvt_f32_i32 v211, v211
    v_cvt_f32_i32 v212, v212
    v_cvt_f32_i32 v213, v213
    v_cvt_f32_i32 v214, v214
    v_cvt_f32_i32 v215, v215
    v_cvt_f32_i32 v216, v216
    v_cvt_f32_i32 v217, v217
    v_cvt_f32_i32 v218, v218
    v_cvt_f32_i32 v219, v219
    v_cvt_f32_i32 v220, v220
    v_cvt_f32_i32 v221, v221
    v_cvt_f32_i32 v222, v222
    v_cvt_f32_i32 v223, v223
    v_cvt_pk_bf16_f32 v108, v208, v212
    v_cvt_pk_bf16_f32 v109, v216, v220
    v_cvt_pk_bf16_f32 v110, v209, v213
    v_cvt_pk_bf16_f32 v111, v217, v221
    v_cvt_pk_bf16_f32 v112, v210, v214
    v_cvt_pk_bf16_f32 v113, v218, v222
    v_cvt_pk_bf16_f32 v114, v211, v215
    v_cvt_pk_bf16_f32 v115, v219, v223
    s_add_u32 s6, s4, 0x18000
    s_waitcnt vmcnt(1)
    buffer_load_dwordx4 v[192:195], v130, s[40:43], s6 offen offset:0 nt
    buffer_load_dwordx4 v[196:199], v130, s[40:43], s6 offen offset:512 nt
    buffer_load_dwordx4 v[200:203], v130, s[40:43], s6 offen offset:1024 nt
    buffer_load_dwordx4 v[204:207], v130, s[40:43], s6 offen offset:1536 nt
    buffer_load_dwordx4 v[208:211], v130, s[40:43], s6 offen offset:256 nt
    buffer_load_dwordx4 v[212:215], v130, s[40:43], s6 offen offset:768 nt
    buffer_load_dwordx4 v[216:219], v130, s[40:43], s6 offen offset:1280 nt
    buffer_load_dwordx4 v[220:223], v130, s[40:43], s6 offen offset:1792 nt
    v_mfma_f32_16x16x16_bf16 v[16:19], v[108:109], v[144:145], 0
    v_mfma_f32_16x16x16_bf16 v[20:23], v[110:111], v[144:145], 0
    v_mfma_f32_16x16x16_bf16 v[24:27], v[112:113], v[144:145], 0
    v_mfma_f32_16x16x16_bf16 v[28:31], v[114:115], v[144:145], 0
    v_fma_f32 v40, v40, s13, -v123
    v_fma_f32 v41, v41, s13, -v123
    v_fma_f32 v42, v42, s13, -v123
    v_fma_f32 v43, v43, s13, -v123
    v_exp_f32 v40, v40
    v_exp_f32 v41, v41
    v_exp_f32 v42, v42
    v_exp_f32 v43, v43
    s_waitcnt lgkmcnt(0)
    v_lshlrev_b32 v124, 16, v148
    v_and_b32 v125, s14, v148
    v_lshlrev_b32 v126, 16, v149
    v_and_b32 v127, s14, v149
    ds_read_b64 v[152:153], v135 offset:22912
    ds_read_b64 v[154:155], v135 offset:24960
    v_add_f32 v156, v40, v41
    v_add_f32 v157, v42, v43
    v_mul_f32 v40, v40, v124
    v_mul_f32 v41, v41, v125
    v_mul_f32 v42, v42, v126
    v_mul_f32 v43, v43, v127
    v_add_f32 v156, v156, v157
    v_and_b32 v124, v133, v40
    v_and_b32 v125, v133, v41
    v_and_b32 v126, v133, v42
    v_and_b32 v127, v133, v43
    v_add_f32 v158, v158, v156
    v_sub_f32 v40, v40, v124
    v_sub_f32 v41, v41, v125
    v_sub_f32 v42, v42, v126
    v_sub_f32 v43, v43, v127
    v_perm_b32 v144, v41, v40, s12
    v_perm_b32 v145, v43, v42, s12
    s_nop 1
    v_mfma_f32_16x16x16_bf16 v[96:99], v[150:151], v[144:145], v[96:99]
    s_mul_i32 s64, s3, 4608
    v_add_u32 v117, s64, v117
    v_lshrrev_b32 v100, 5, v116
    s_lshl_b32 s64, s3, 1
    v_add_u32 v100, s64, v100
    v_mul_u32_u24 v118, 528, v100
    v_add_u32 v118, v134, v118
    v_lshlrev_b32 v121, 4, v100
    v_lshlrev_b32 v119, 10, v100
    v_lshl_add_u32 v119, v134, 1, v119
    s_lshl_b32 s22, s2, 13
    s_cmp_lg_u32 s3, 3
    s_cbranch_scc1 L_no_nonce2
    v_readfirstlane_b32 s64, v136
    s_nop 3
    s_cmp_eq_u32 s64, 0
    s_cselect_b32 s64, s70, s64
    v_mov_b32 v136, s64
    v_mov_b32 v137, 0
    ds_write_b32 v137, v136 offset:28928
L_no_nonce2:
    v_lshrrev_b32 v138, 3, v116
    v_lshlrev_b32 v138, 13, v138
    v_lshl_add_u32 v138, v122, 4, v138
    v_lshlrev_b32 v139, 2, v122
    v_mov_b32 v137, 0
    v_lshlrev_b32 v140, 4, v122
    s_lshl_b32 s64, s3, 2
    v_add_u32 v140, s64, v140
    ds_write_b32 v140, v123 offset:28672
    s_and_b32 s64, s67, 1
    s_lshl_b32 s64, s64, 4
    s_lshr_b32 s67, s67, 1
    s_or_b32 s67, s67, s64
    s_lshl_b32 s16, s15, 18
    s_lshl_b32 s17, s67, 9
    s_add_u32 s16, s16, s17
    s_lshl_b32 s17, s3, 7
    s_add_u32 s16, s16, s17
    s_add_u32 s17, s16, 0x10000
    s_add_u32 s18, s16, 0x20000
    s_add_u32 s19, s16, 0x30000
    s_lshl_b32 s20, s15, 11
    s_lshl_b32 s21, s67, 7
    s_add_u32 s20, s20, s21
    s_lshl_b32 s21, s3, 5
    s_add_u32 s20, s20, s21
    s_mov_b32 s21, 0x1000000
    s_waitcnt vmcnt(20)
    v_cvt_f32_i32 v224, v224
    v_cvt_f32_i32 v225, v225
    v_cvt_f32_i32 v226, v226
    v_cvt_f32_i32 v227, v227
    v_cvt_f32_i32 v228, v228
    v_cvt_f32_i32 v229, v229
    v_cvt_f32_i32 v230, v230
    v_cvt_f32_i32 v231, v231
    v_cvt_f32_i32 v232, v232
    v_cvt_f32_i32 v233, v233
    v_cvt_f32_i32 v234, v234
    v_cvt_f32_i32 v235, v235
    v_cvt_f32_i32 v236, v236
    v_cvt_f32_i32 v237, v237
    v_cvt_f32_i32 v238, v238
    v_cvt_f32_i32 v239, v239
    v_cvt_pk_bf16_f32 v100, v224, v228
    v_cvt_pk_bf16_f32 v101, v232, v236
    v_cvt_pk_bf16_f32 v102, v225, v229
    v_cvt_pk_bf16_f32 v103, v233, v237
    v_cvt_pk_bf16_f32 v104, v226, v230
    v_cvt_pk_bf16_f32 v105, v234, v238
    v_cvt_pk_bf16_f32 v106, v227, v231
    v_cvt_pk_bf16_f32 v107, v235, v239
    v_mfma_f32_16x16x16_bf16 v[0:3], v[100:101], v[146:147], v[0:3]
    v_mfma_f32_16x16x16_bf16 v[4:7], v[102:103], v[146:147], v[4:7]
    v_mfma_f32_16x16x16_bf16 v[8:11], v[104:105], v[146:147], v[8:11]
    v_mfma_f32_16x16x16_bf16 v[12:15], v[106:107], v[146:147], v[12:15]
    s_waitcnt vmcnt(16)
    v_cvt_f32_i32 v240, v240
    v_cvt_f32_i32 v241, v241
    v_cvt_f32_i32 v242, v242
    v_cvt_f32_i32 v243, v243
    v_cvt_f32_i32 v244, v244
    v_cvt_f32_i32 v245, v245
    v_cvt_f32_i32 v246, v246
    v_cvt_f32_i32 v247, v247
    v_cvt_f32_i32 v248, v248
    v_cvt_f32_i32 v249, v249
    v_cvt_f32_i32 v250, v250
    v_cvt_f32_i32 v251, v251
    v_cvt_f32_i32 v252, v252
    v_cvt_f32_i32 v253, v253
    v_cvt_f32_i32 v254, v254
    v_cvt_f32_i32 v255, v255
    v_cvt_pk_bf16_f32 v108, v240, v244
    v_cvt_pk_bf16_f32 v109, v248, v252
    v_cvt_pk_bf16_f32 v110, v241, v245
    v_cvt_pk_bf16_f32 v111, v249, v253
    v_cvt_pk_bf16_f32 v112, v242, v246
    v_cvt_pk_bf16_f32 v113, v250, v254
    v_cvt_pk_bf16_f32 v114, v243, v247
    v_cvt_pk_bf16_f32 v115, v251, v255
    s_add_u32 s5, s4, 0x400000
    s_waitcnt vmcnt(1)
    buffer_load_dwordx4 v[224:227], v130, s[40:43], s5 offen offset:0 nt
    buffer_load_dwordx4 v[228:231], v130, s[40:43], s5 offen offset:512 nt
    buffer_load_dwordx4 v[232:235], v130, s[40:43], s5 offen offset:1024 nt
    buffer_load_dwordx4 v[236:239], v130, s[40:43], s5 offen offset:1536 nt
    buffer_load_dwordx4 v[240:243], v130, s[40:43], s5 offen offset:256 nt
    buffer_load_dwordx4 v[244:247], v130, s[40:43], s5 offen offset:768 nt
    buffer_load_dwordx4 v[248:251], v130, s[40:43], s5 offen offset:1280 nt
    buffer_load_dwordx4 v[252:255], v130, s[40:43], s5 offen offset:1792 nt
    v_mfma_f32_16x16x16_bf16 v[16:19], v[108:109], v[146:147], v[16:19]
    v_mfma_f32_16x16x16_bf16 v[20:23], v[110:111], v[146:147], v[20:23]
    v_mfma_f32_16x16x16_bf16 v[24:27], v[112:113], v[146:147], v[24:27]
    v_mfma_f32_16x16x16_bf16 v[28:31], v[114:115], v[146:147], v[28:31]
    v_fma_f32 v44, v44, s13, -v123
    v_fma_f32 v45, v45, s13, -v123
    v_fma_f32 v46, v46, s13, -v123
    v_fma_f32 v47, v47, s13, -v123
    v_exp_f32 v44, v44
    v_exp_f32 v45, v45
    v_exp_f32 v46, v46
    v_exp_f32 v47, v47
    s_waitcnt lgkmcnt(0)
    v_lshlrev_b32 v124, 16, v152
    v_and_b32 v125, s14, v152
    v_lshlrev_b32 v126, 16, v153
    v_and_b32 v127, s14, v153
    ds_read_b64 v[148:149], v135 offset:23040
    ds_read_b64 v[150:151], v135 offset:25088
    v_add_f32 v156, v44, v45
    v_add_f32 v157, v46, v47
    v_mul_f32 v44, v44, v124
    v_mul_f32 v45, v45, v125
    v_mul_f32 v46, v46, v126
    v_mul_f32 v47, v47, v127
    v_add_f32 v156, v156, v157
    v_and_b32 v124, v133, v44
    v_and_b32 v125, v133, v45
    v_and_b32 v126, v133, v46
    v_and_b32 v127, v133, v47
    v_add_f32 v158, v158, v156
    v_sub_f32 v44, v44, v124
    v_sub_f32 v45, v45, v125
    v_sub_f32 v46, v46, v126
    v_sub_f32 v47, v47, v127
    v_perm_b32 v146, v45, v44, s12
    v_perm_b32 v147, v47, v46, s12
    s_nop 1
    v_mfma_f32_16x16x16_bf16 v[96:99], v[154:155], v[146:147], v[96:99]
    s_waitcnt vmcnt(20)
    v_cvt_f32_i32 v160, v160
    v_cvt_f32_i32 v161, v161
    v_cvt_f32_i32 v162, v162
    v_cvt_f32_i32 v163, v163
    v_cvt_f32_i32 v164, v164
    v_cvt_f32_i32 v165, v165
    v_cvt_f32_i32 v166, v166
    v_cvt_f32_i32 v167, v167
    v_cvt_f32_i32 v168, v168
    v_cvt_f32_i32 v169, v169
    v_cvt_f32_i32 v170, v170
    v_cvt_f32_i32 v171, v171
    v_cvt_f32_i32 v172, v172
    v_cvt_f32_i32 v173, v173
    v_cvt_f32_i32 v174, v174
    v_cvt_f32_i32 v175, v175
    v_cvt_pk_bf16_f32 v100, v160, v164
    v_cvt_pk_bf16_f32 v101, v168, v172
    v_cvt_pk_bf16_f32 v102, v161, v165
    v_cvt_pk_bf16_f32 v103, v169, v173
    v_cvt_pk_bf16_f32 v104, v162, v166
    v_cvt_pk_bf16_f32 v105, v170, v174
    v_cvt_pk_bf16_f32 v106, v163, v167
    v_cvt_pk_bf16_f32 v107, v171, v175
    v_mfma_f32_16x16x16_bf16 v[0:3], v[100:101], v[144:145], v[0:3]
    v_mfma_f32_16x16x16_bf16 v[4:7], v[102:103], v[144:145], v[4:7]
    v_mfma_f32_16x16x16_bf16 v[8:11], v[104:105], v[144:145], v[8:11]
    v_mfma_f32_16x16x16_bf16 v[12:15], v[106:107], v[144:145], v[12:15]
    s_waitcnt vmcnt(16)
    v_cvt_f32_i32 v176, v176
    v_cvt_f32_i32 v177, v177
    v_cvt_f32_i32 v178, v178
    v_cvt_f32_i32 v179, v179
    v_cvt_f32_i32 v180, v180
    v_cvt_f32_i32 v181, v181
    v_cvt_f32_i32 v182, v182
    v_cvt_f32_i32 v183, v183
    v_cvt_f32_i32 v184, v184
    v_cvt_f32_i32 v185, v185
    v_cvt_f32_i32 v186, v186
    v_cvt_f32_i32 v187, v187
    v_cvt_f32_i32 v188, v188
    v_cvt_f32_i32 v189, v189
    v_cvt_f32_i32 v190, v190
    v_cvt_f32_i32 v191, v191
    v_cvt_pk_bf16_f32 v108, v176, v180
    v_cvt_pk_bf16_f32 v109, v184, v188
    v_cvt_pk_bf16_f32 v110, v177, v181
    v_cvt_pk_bf16_f32 v111, v185, v189
    v_cvt_pk_bf16_f32 v112, v178, v182
    v_cvt_pk_bf16_f32 v113, v186, v190
    v_cvt_pk_bf16_f32 v114, v179, v183
    v_cvt_pk_bf16_f32 v115, v187, v191
    s_add_u32 s6, s4, 0x408000
    s_waitcnt vmcnt(1)
    buffer_load_dwordx4 v[160:163], v130, s[40:43], s6 offen offset:0 nt
    buffer_load_dwordx4 v[164:167], v130, s[40:43], s6 offen offset:512 nt
    buffer_load_dwordx4 v[168:171], v130, s[40:43], s6 offen offset:1024 nt
    buffer_load_dwordx4 v[172:175], v130, s[40:43], s6 offen offset:1536 nt
    buffer_load_dwordx4 v[176:179], v130, s[40:43], s6 offen offset:256 nt
    buffer_load_dwordx4 v[180:183], v130, s[40:43], s6 offen offset:768 nt
    buffer_load_dwordx4 v[184:187], v130, s[40:43], s6 offen offset:1280 nt
    buffer_load_dwordx4 v[188:191], v130, s[40:43], s6 offen offset:1792 nt
    v_mfma_f32_16x16x16_bf16 v[16:19], v[108:109], v[144:145], v[16:19]
    v_mfma_f32_16x16x16_bf16 v[20:23], v[110:111], v[144:145], v[20:23]
    v_mfma_f32_16x16x16_bf16 v[24:27], v[112:113], v[144:145], v[24:27]
    v_mfma_f32_16x16x16_bf16 v[28:31], v[114:115], v[144:145], v[28:31]
    v_fma_f32 v48, v48, s13, -v123
    v_fma_f32 v49, v49, s13, -v123
    v_fma_f32 v50, v50, s13, -v123
    v_fma_f32 v51, v51, s13, -v123
    v_exp_f32 v48, v48
    v_exp_f32 v49, v49
    v_exp_f32 v50, v50
    v_exp_f32 v51, v51
    s_waitcnt lgkmcnt(0)
    v_lshlrev_b32 v124, 16, v148
    v_and_b32 v125, s14, v148
    v_lshlrev_b32 v126, 16, v149
    v_and_b32 v127, s14, v149
    ds_read_b64 v[152:153], v135 offset:23168
    ds_read_b64 v[154:155], v135 offset:25216
    v_add_f32 v156, v48, v49
    v_add_f32 v157, v50, v51
    v_mul_f32 v48, v48, v124
    v_mul_f32 v49, v49, v125
    v_mul_f32 v50, v50, v126
    v_mul_f32 v51, v51, v127
    v_add_f32 v156, v156, v157
    v_and_b32 v124, v133, v48
    v_and_b32 v125, v133, v49
    v_and_b32 v126, v133, v50
    v_and_b32 v127, v133, v51
    v_add_f32 v158, v158, v156
    v_sub_f32 v48, v48, v124
    v_sub_f32 v49, v49, v125
    v_sub_f32 v50, v50, v126
    v_sub_f32 v51, v51, v127
    v_perm_b32 v144, v49, v48, s12
    v_perm_b32 v145, v51, v50, s12
    s_nop 1
    v_mfma_f32_16x16x16_bf16 v[96:99], v[150:151], v[144:145], v[96:99]
    s_waitcnt vmcnt(20)
    v_cvt_f32_i32 v192, v192
    v_cvt_f32_i32 v193, v193
    v_cvt_f32_i32 v194, v194
    v_cvt_f32_i32 v195, v195
    v_cvt_f32_i32 v196, v196
    v_cvt_f32_i32 v197, v197
    v_cvt_f32_i32 v198, v198
    v_cvt_f32_i32 v199, v199
    v_cvt_f32_i32 v200, v200
    v_cvt_f32_i32 v201, v201
    v_cvt_f32_i32 v202, v202
    v_cvt_f32_i32 v203, v203
    v_cvt_f32_i32 v204, v204
    v_cvt_f32_i32 v205, v205
    v_cvt_f32_i32 v206, v206
    v_cvt_f32_i32 v207, v207
    v_cvt_pk_bf16_f32 v100, v192, v196
    v_cvt_pk_bf16_f32 v101, v200, v204
    v_cvt_pk_bf16_f32 v102, v193, v197
    v_cvt_pk_bf16_f32 v103, v201, v205
    v_cvt_pk_bf16_f32 v104, v194, v198
    v_cvt_pk_bf16_f32 v105, v202, v206
    v_cvt_pk_bf16_f32 v106, v195, v199
    v_cvt_pk_bf16_f32 v107, v203, v207
    v_mfma_f32_16x16x16_bf16 v[0:3], v[100:101], v[146:147], v[0:3]
    v_mfma_f32_16x16x16_bf16 v[4:7], v[102:103], v[146:147], v[4:7]
    v_mfma_f32_16x16x16_bf16 v[8:11], v[104:105], v[146:147], v[8:11]
    v_mfma_f32_16x16x16_bf16 v[12:15], v[106:107], v[146:147], v[12:15]
    s_waitcnt vmcnt(16)
    v_cvt_f32_i32 v208, v208
    v_cvt_f32_i32 v209, v209
    v_cvt_f32_i32 v210, v210
    v_cvt_f32_i32 v211, v211
    v_cvt_f32_i32 v212, v212
    v_cvt_f32_i32 v213, v213
    v_cvt_f32_i32 v214, v214
    v_cvt_f32_i32 v215, v215
    v_cvt_f32_i32 v216, v216
    v_cvt_f32_i32 v217, v217
    v_cvt_f32_i32 v218, v218
    v_cvt_f32_i32 v219, v219
    v_cvt_f32_i32 v220, v220
    v_cvt_f32_i32 v221, v221
    v_cvt_f32_i32 v222, v222
    v_cvt_f32_i32 v223, v223
    v_cvt_pk_bf16_f32 v108, v208, v212
    v_cvt_pk_bf16_f32 v109, v216, v220
    v_cvt_pk_bf16_f32 v110, v209, v213
    v_cvt_pk_bf16_f32 v111, v217, v221
    v_cvt_pk_bf16_f32 v112, v210, v214
    v_cvt_pk_bf16_f32 v113, v218, v222
    v_cvt_pk_bf16_f32 v114, v211, v215
    v_cvt_pk_bf16_f32 v115, v219, v223
    s_add_u32 s5, s4, 0x410000
    s_waitcnt vmcnt(1)
    buffer_load_dwordx4 v[192:195], v130, s[40:43], s5 offen offset:0 nt
    buffer_load_dwordx4 v[196:199], v130, s[40:43], s5 offen offset:512 nt
    buffer_load_dwordx4 v[200:203], v130, s[40:43], s5 offen offset:1024 nt
    buffer_load_dwordx4 v[204:207], v130, s[40:43], s5 offen offset:1536 nt
    buffer_load_dwordx4 v[208:211], v130, s[40:43], s5 offen offset:256 nt
    buffer_load_dwordx4 v[212:215], v130, s[40:43], s5 offen offset:768 nt
    buffer_load_dwordx4 v[216:219], v130, s[40:43], s5 offen offset:1280 nt
    buffer_load_dwordx4 v[220:223], v130, s[40:43], s5 offen offset:1792 nt
    v_mfma_f32_16x16x16_bf16 v[16:19], v[108:109], v[146:147], v[16:19]
    v_mfma_f32_16x16x16_bf16 v[20:23], v[110:111], v[146:147], v[20:23]
    v_mfma_f32_16x16x16_bf16 v[24:27], v[112:113], v[146:147], v[24:27]
    v_mfma_f32_16x16x16_bf16 v[28:31], v[114:115], v[146:147], v[28:31]
    v_fma_f32 v52, v52, s13, -v123
    v_fma_f32 v53, v53, s13, -v123
    v_fma_f32 v54, v54, s13, -v123
    v_fma_f32 v55, v55, s13, -v123
    v_exp_f32 v52, v52
    v_exp_f32 v53, v53
    v_exp_f32 v54, v54
    v_exp_f32 v55, v55
    s_waitcnt lgkmcnt(0)
    v_lshlrev_b32 v124, 16, v152
    v_and_b32 v125, s14, v152
    v_lshlrev_b32 v126, 16, v153
    v_and_b32 v127, s14, v153
    ds_read_b64 v[148:149], v135 offset:23296
    ds_read_b64 v[150:151], v135 offset:25344
    v_add_f32 v156, v52, v53
    v_add_f32 v157, v54, v55
    v_mul_f32 v52, v52, v124
    v_mul_f32 v53, v53, v125
    v_mul_f32 v54, v54, v126
    v_mul_f32 v55, v55, v127
    v_add_f32 v156, v156, v157
    v_and_b32 v124, v133, v52
    v_and_b32 v125, v133, v53
    v_and_b32 v126, v133, v54
    v_and_b32 v127, v133, v55
    v_add_f32 v158, v158, v156
    v_sub_f32 v52, v52, v124
    v_sub_f32 v53, v53, v125
    v_sub_f32 v54, v54, v126
    v_sub_f32 v55, v55, v127
    v_perm_b32 v146, v53, v52, s12
    v_perm_b32 v147, v55, v54, s12
    s_nop 1
    v_mfma_f32_16x16x16_bf16 v[96:99], v[154:155], v[146:147], v[96:99]
    s_waitcnt vmcnt(20)
    v_cvt_f32_i32 v224, v224
    v_cvt_f32_i32 v225, v225
    v_cvt_f32_i32 v226, v226
    v_cvt_f32_i32 v227, v227
    v_cvt_f32_i32 v228, v228
    v_cvt_f32_i32 v229, v229
    v_cvt_f32_i32 v230, v230
    v_cvt_f32_i32 v231, v231
    v_cvt_f32_i32 v232, v232
    v_cvt_f32_i32 v233, v233
    v_cvt_f32_i32 v234, v234
    v_cvt_f32_i32 v235, v235
    v_cvt_f32_i32 v236, v236
    v_cvt_f32_i32 v237, v237
    v_cvt_f32_i32 v238, v238
    v_cvt_f32_i32 v239, v239
    v_cvt_pk_bf16_f32 v100, v224, v228
    v_cvt_pk_bf16_f32 v101, v232, v236
    v_cvt_pk_bf16_f32 v102, v225, v229
    v_cvt_pk_bf16_f32 v103, v233, v237
    v_cvt_pk_bf16_f32 v104, v226, v230
    v_cvt_pk_bf16_f32 v105, v234, v238
    v_cvt_pk_bf16_f32 v106, v227, v231
    v_cvt_pk_bf16_f32 v107, v235, v239
    v_mfma_f32_16x16x16_bf16 v[0:3], v[100:101], v[144:145], v[0:3]
    v_mfma_f32_16x16x16_bf16 v[4:7], v[102:103], v[144:145], v[4:7]
    v_mfma_f32_16x16x16_bf16 v[8:11], v[104:105], v[144:145], v[8:11]
    v_mfma_f32_16x16x16_bf16 v[12:15], v[106:107], v[144:145], v[12:15]
    s_waitcnt vmcnt(16)
    v_cvt_f32_i32 v240, v240
    v_cvt_f32_i32 v241, v241
    v_cvt_f32_i32 v242, v242
    v_cvt_f32_i32 v243, v243
    v_cvt_f32_i32 v244, v244
    v_cvt_f32_i32 v245, v245
    v_cvt_f32_i32 v246, v246
    v_cvt_f32_i32 v247, v247
    v_cvt_f32_i32 v248, v248
    v_cvt_f32_i32 v249, v249
    v_cvt_f32_i32 v250, v250
    v_cvt_f32_i32 v251, v251
    v_cvt_f32_i32 v252, v252
    v_cvt_f32_i32 v253, v253
    v_cvt_f32_i32 v254, v254
    v_cvt_f32_i32 v255, v255
    v_cvt_pk_bf16_f32 v108, v240, v244
    v_cvt_pk_bf16_f32 v109, v248, v252
    v_cvt_pk_bf16_f32 v110, v241, v245
    v_cvt_pk_bf16_f32 v111, v249, v253
    v_cvt_pk_bf16_f32 v112, v242, v246
    v_cvt_pk_bf16_f32 v113, v250, v254
    v_cvt_pk_bf16_f32 v114, v243, v247
    v_cvt_pk_bf16_f32 v115, v251, v255
    s_add_u32 s6, s4, 0x418000
    s_waitcnt vmcnt(1)
    buffer_load_dwordx4 v[224:227], v130, s[40:43], s6 offen offset:0 nt
    buffer_load_dwordx4 v[228:231], v130, s[40:43], s6 offen offset:512 nt
    buffer_load_dwordx4 v[232:235], v130, s[40:43], s6 offen offset:1024 nt
    buffer_load_dwordx4 v[236:239], v130, s[40:43], s6 offen offset:1536 nt
    buffer_load_dwordx4 v[240:243], v130, s[40:43], s6 offen offset:256 nt
    buffer_load_dwordx4 v[244:247], v130, s[40:43], s6 offen offset:768 nt
    buffer_load_dwordx4 v[248:251], v130, s[40:43], s6 offen offset:1280 nt
    buffer_load_dwordx4 v[252:255], v130, s[40:43], s6 offen offset:1792 nt
    v_mfma_f32_16x16x16_bf16 v[16:19], v[108:109], v[144:145], v[16:19]
    v_mfma_f32_16x16x16_bf16 v[20:23], v[110:111], v[144:145], v[20:23]
    v_mfma_f32_16x16x16_bf16 v[24:27], v[112:113], v[144:145], v[24:27]
    v_mfma_f32_16x16x16_bf16 v[28:31], v[114:115], v[144:145], v[28:31]
    v_fma_f32 v56, v56, s13, -v123
    v_fma_f32 v57, v57, s13, -v123
    v_fma_f32 v58, v58, s13, -v123
    v_fma_f32 v59, v59, s13, -v123
    v_exp_f32 v56, v56
    v_exp_f32 v57, v57
    v_exp_f32 v58, v58
    v_exp_f32 v59, v59
    s_waitcnt lgkmcnt(0)
    v_lshlrev_b32 v124, 16, v148
    v_and_b32 v125, s14, v148
    v_lshlrev_b32 v126, 16, v149
    v_and_b32 v127, s14, v149
    ds_read_b64 v[152:153], v135 offset:23424
    ds_read_b64 v[154:155], v135 offset:25472
    v_add_f32 v156, v56, v57
    v_add_f32 v157, v58, v59
    v_mul_f32 v56, v56, v124
    v_mul_f32 v57, v57, v125
    v_mul_f32 v58, v58, v126
    v_mul_f32 v59, v59, v127
    v_add_f32 v156, v156, v157
    v_and_b32 v124, v133, v56
    v_and_b32 v125, v133, v57
    v_and_b32 v126, v133, v58
    v_and_b32 v127, v133, v59
    v_add_f32 v158, v158, v156
    v_sub_f32 v56, v56, v124
    v_sub_f32 v57, v57, v125
    v_sub_f32 v58, v58, v126
    v_sub_f32 v59, v59, v127
    v_perm_b32 v144, v57, v56, s12
    v_perm_b32 v145, v59, v58, s12
    s_nop 1
    v_mfma_f32_16x16x16_bf16 v[96:99], v[150:151], v[144:145], v[96:99]
    s_waitcnt vmcnt(20)
    v_cvt_f32_i32 v160, v160
    v_cvt_f32_i32 v161, v161
    v_cvt_f32_i32 v162, v162
    v_cvt_f32_i32 v163, v163
    v_cvt_f32_i32 v164, v164
    v_cvt_f32_i32 v165, v165
    v_cvt_f32_i32 v166, v166
    v_cvt_f32_i32 v167, v167
    v_cvt_f32_i32 v168, v168
    v_cvt_f32_i32 v169, v169
    v_cvt_f32_i32 v170, v170
    v_cvt_f32_i32 v171, v171
    v_cvt_f32_i32 v172, v172
    v_cvt_f32_i32 v173, v173
    v_cvt_f32_i32 v174, v174
    v_cvt_f32_i32 v175, v175
    v_cvt_pk_bf16_f32 v100, v160, v164
    v_cvt_pk_bf16_f32 v101, v168, v172
    v_cvt_pk_bf16_f32 v102, v161, v165
    v_cvt_pk_bf16_f32 v103, v169, v173
    v_cvt_pk_bf16_f32 v104, v162, v166
    v_cvt_pk_bf16_f32 v105, v170, v174
    v_cvt_pk_bf16_f32 v106, v163, v167
    v_cvt_pk_bf16_f32 v107, v171, v175
    v_mfma_f32_16x16x16_bf16 v[0:3], v[100:101], v[146:147], v[0:3]
    v_mfma_f32_16x16x16_bf16 v[4:7], v[102:103], v[146:147], v[4:7]
    v_mfma_f32_16x16x16_bf16 v[8:11], v[104:105], v[146:147], v[8:11]
    v_mfma_f32_16x16x16_bf16 v[12:15], v[106:107], v[146:147], v[12:15]
    s_waitcnt vmcnt(16)
    v_cvt_f32_i32 v176, v176
    v_cvt_f32_i32 v177, v177
    v_cvt_f32_i32 v178, v178
    v_cvt_f32_i32 v179, v179
    v_cvt_f32_i32 v180, v180
    v_cvt_f32_i32 v181, v181
    v_cvt_f32_i32 v182, v182
    v_cvt_f32_i32 v183, v183
    v_cvt_f32_i32 v184, v184
    v_cvt_f32_i32 v185, v185
    v_cvt_f32_i32 v186, v186
    v_cvt_f32_i32 v187, v187
    v_cvt_f32_i32 v188, v188
    v_cvt_f32_i32 v189, v189
    v_cvt_f32_i32 v190, v190
    v_cvt_f32_i32 v191, v191
    v_cvt_pk_bf16_f32 v108, v176, v180
    v_cvt_pk_bf16_f32 v109, v184, v188
    v_cvt_pk_bf16_f32 v110, v177, v181
    v_cvt_pk_bf16_f32 v111, v185, v189
    v_cvt_pk_bf16_f32 v112, v178, v182
    v_cvt_pk_bf16_f32 v113, v186, v190
    v_cvt_pk_bf16_f32 v114, v179, v183
    v_cvt_pk_bf16_f32 v115, v187, v191
    s_add_u32 s5, s4, 0x800000
    s_waitcnt vmcnt(1)
    buffer_load_dwordx4 v[160:163], v130, s[40:43], s5 offen offset:0 nt
    buffer_load_dwordx4 v[164:167], v130, s[40:43], s5 offen offset:512 nt
    buffer_load_dwordx4 v[168:171], v130, s[40:43], s5 offen offset:1024 nt
    buffer_load_dwordx4 v[172:175], v130, s[40:43], s5 offen offset:1536 nt
    buffer_load_dwordx4 v[176:179], v130, s[40:43], s5 offen offset:256 nt
    buffer_load_dwordx4 v[180:183], v130, s[40:43], s5 offen offset:768 nt
    buffer_load_dwordx4 v[184:187], v130, s[40:43], s5 offen offset:1280 nt
    buffer_load_dwordx4 v[188:191], v130, s[40:43], s5 offen offset:1792 nt
    v_mfma_f32_16x16x16_bf16 v[16:19], v[108:109], v[146:147], v[16:19]
    v_mfma_f32_16x16x16_bf16 v[20:23], v[110:111], v[146:147], v[20:23]
    v_mfma_f32_16x16x16_bf16 v[24:27], v[112:113], v[146:147], v[24:27]
    v_mfma_f32_16x16x16_bf16 v[28:31], v[114:115], v[146:147], v[28:31]
    v_fma_f32 v60, v60, s13, -v123
    v_fma_f32 v61, v61, s13, -v123
    v_fma_f32 v62, v62, s13, -v123
    v_fma_f32 v63, v63, s13, -v123
    v_exp_f32 v60, v60
    v_exp_f32 v61, v61
    v_exp_f32 v62, v62
    v_exp_f32 v63, v63
    s_waitcnt lgkmcnt(0)
    v_lshlrev_b32 v124, 16, v152
    v_and_b32 v125, s14, v152
    v_lshlrev_b32 v126, 16, v153
    v_and_b32 v127, s14, v153
    ds_read_b64 v[148:149], v135 offset:23552
    ds_read_b64 v[150:151], v135 offset:25600
    v_add_f32 v156, v60, v61
    v_add_f32 v157, v62, v63
    v_mul_f32 v60, v60, v124
    v_mul_f32 v61, v61, v125
    v_mul_f32 v62, v62, v126
    v_mul_f32 v63, v63, v127
    v_add_f32 v156, v156, v157
    v_and_b32 v124, v133, v60
    v_and_b32 v125, v133, v61
    v_and_b32 v126, v133, v62
    v_and_b32 v127, v133, v63
    v_add_f32 v158, v158, v156
    v_sub_f32 v60, v60, v124
    v_sub_f32 v61, v61, v125
    v_sub_f32 v62, v62, v126
    v_sub_f32 v63, v63, v127
    v_perm_b32 v146, v61, v60, s12
    v_perm_b32 v147, v63, v62, s12
    s_nop 1
    v_mfma_f32_16x16x16_bf16 v[96:99], v[154:155], v[146:147], v[96:99]
    s_waitcnt vmcnt(20)
    v_cvt_f32_i32 v192, v192
    v_cvt_f32_i32 v193, v193
    v_cvt_f32_i32 v194, v194
    v_cvt_f32_i32 v195, v195
    v_cvt_f32_i32 v196, v196
    v_cvt_f32_i32 v197, v197
    v_cvt_f32_i32 v198, v198
    v_cvt_f32_i32 v199, v199
    v_cvt_f32_i32 v200, v200
    v_cvt_f32_i32 v201, v201
    v_cvt_f32_i32 v202, v202
    v_cvt_f32_i32 v203, v203
    v_cvt_f32_i32 v204, v204
    v_cvt_f32_i32 v205, v205
    v_cvt_f32_i32 v206, v206
    v_cvt_f32_i32 v207, v207
    v_cvt_pk_bf16_f32 v100, v192, v196
    v_cvt_pk_bf16_f32 v101, v200, v204
    v_cvt_pk_bf16_f32 v102, v193, v197
    v_cvt_pk_bf16_f32 v103, v201, v205
    v_cvt_pk_bf16_f32 v104, v194, v198
    v_cvt_pk_bf16_f32 v105, v202, v206
    v_cvt_pk_bf16_f32 v106, v195, v199
    v_cvt_pk_bf16_f32 v107, v203, v207
    v_mfma_f32_16x16x16_bf16 v[0:3], v[100:101], v[144:145], v[0:3]
    v_mfma_f32_16x16x16_bf16 v[4:7], v[102:103], v[144:145], v[4:7]
    v_mfma_f32_16x16x16_bf16 v[8:11], v[104:105], v[144:145], v[8:11]
    v_mfma_f32_16x16x16_bf16 v[12:15], v[106:107], v[144:145], v[12:15]
    s_waitcnt vmcnt(16)
    v_cvt_f32_i32 v208, v208
    v_cvt_f32_i32 v209, v209
    v_cvt_f32_i32 v210, v210
    v_cvt_f32_i32 v211, v211
    v_cvt_f32_i32 v212, v212
    v_cvt_f32_i32 v213, v213
    v_cvt_f32_i32 v214, v214
    v_cvt_f32_i32 v215, v215
    v_cvt_f32_i32 v216, v216
    v_cvt_f32_i32 v217, v217
    v_cvt_f32_i32 v218, v218
    v_cvt_f32_i32 v219, v219
    v_cvt_f32_i32 v220, v220
    v_cvt_f32_i32 v221, v221
    v_cvt_f32_i32 v222, v222
    v_cvt_f32_i32 v223, v223
    v_cvt_pk_bf16_f32 v108, v208, v212
    v_cvt_pk_bf16_f32 v109, v216, v220
    v_cvt_pk_bf16_f32 v110, v209, v213
    v_cvt_pk_bf16_f32 v111, v217, v221
    v_cvt_pk_bf16_f32 v112, v210, v214
    v_cvt_pk_bf16_f32 v113, v218, v222
    v_cvt_pk_bf16_f32 v114, v211, v215
    v_cvt_pk_bf16_f32 v115, v219, v223
    s_add_u32 s6, s4, 0x808000
    s_waitcnt vmcnt(1)
    buffer_load_dwordx4 v[192:195], v130, s[40:43], s6 offen offset:0 nt
    buffer_load_dwordx4 v[196:199], v130, s[40:43], s6 offen offset:512 nt
    buffer_load_dwordx4 v[200:203], v130, s[40:43], s6 offen offset:1024 nt
    buffer_load_dwordx4 v[204:207], v130, s[40:43], s6 offen offset:1536 nt
    buffer_load_dwordx4 v[208:211], v130, s[40:43], s6 offen offset:256 nt
    buffer_load_dwordx4 v[212:215], v130, s[40:43], s6 offen offset:768 nt
    buffer_load_dwordx4 v[216:219], v130, s[40:43], s6 offen offset:1280 nt
    buffer_load_dwordx4 v[220:223], v130, s[40:43], s6 offen offset:1792 nt
    v_mfma_f32_16x16x16_bf16 v[16:19], v[108:109], v[144:145], v[16:19]
    v_mfma_f32_16x16x16_bf16 v[20:23], v[110:111], v[144:145], v[20:23]
    v_mfma_f32_16x16x16_bf16 v[24:27], v[112:113], v[144:145], v[24:27]
    v_mfma_f32_16x16x16_bf16 v[28:31], v[114:115], v[144:145], v[28:31]
    v_fma_f32 v64, v64, s13, -v123
    v_fma_f32 v65, v65, s13, -v123
    v_fma_f32 v66, v66, s13, -v123
    v_fma_f32 v67, v67, s13, -v123
    v_exp_f32 v64, v64
    v_exp_f32 v65, v65
    v_exp_f32 v66, v66
    v_exp_f32 v67, v67
    s_waitcnt lgkmcnt(0)
    v_lshlrev_b32 v124, 16, v148
    v_and_b32 v125, s14, v148
    v_lshlrev_b32 v126, 16, v149
    v_and_b32 v127, s14, v149
    ds_read_b64 v[152:153], v135 offset:23680
    ds_read_b64 v[154:155], v135 offset:25728
    v_add_f32 v156, v64, v65
    v_add_f32 v157, v66, v67
    v_mul_f32 v64, v64, v124
    v_mul_f32 v65, v65, v125
    v_mul_f32 v66, v66, v126
    v_mul_f32 v67, v67, v127
    v_add_f32 v156, v156, v157
    v_and_b32 v124, v133, v64
    v_and_b32 v125, v133, v65
    v_and_b32 v126, v133, v66
    v_and_b32 v127, v133, v67
    v_add_f32 v158, v158, v156
    v_sub_f32 v64, v64, v124
    v_sub_f32 v65, v65, v125
    v_sub_f32 v66, v66, v126
    v_sub_f32 v67, v67, v127
    v_perm_b32 v144, v65, v64, s12
    v_perm_b32 v145, v67, v66, s12
    s_nop 1
    v_mfma_f32_16x16x16_bf16 v[96:99], v[150:151], v[144:145], v[96:99]
    s_waitcnt vmcnt(20)
    v_cvt_f32_i32 v224, v224
    v_cvt_f32_i32 v225, v225
    v_cvt_f32_i32 v226, v226
    v_cvt_f32_i32 v227, v227
    v_cvt_f32_i32 v228, v228
    v_cvt_f32_i32 v229, v229
    v_cvt_f32_i32 v230, v230
    v_cvt_f32_i32 v231, v231
    v_cvt_f32_i32 v232, v232
    v_cvt_f32_i32 v233, v233
    v_cvt_f32_i32 v234, v234
    v_cvt_f32_i32 v235, v235
    v_cvt_f32_i32 v236, v236
    v_cvt_f32_i32 v237, v237
    v_cvt_f32_i32 v238, v238
    v_cvt_f32_i32 v239, v239
    v_cvt_pk_bf16_f32 v100, v224, v228
    v_cvt_pk_bf16_f32 v101, v232, v236
    v_cvt_pk_bf16_f32 v102, v225, v229
    v_cvt_pk_bf16_f32 v103, v233, v237
    v_cvt_pk_bf16_f32 v104, v226, v230
    v_cvt_pk_bf16_f32 v105, v234, v238
    v_cvt_pk_bf16_f32 v106, v227, v231
    v_cvt_pk_bf16_f32 v107, v235, v239
    v_mfma_f32_16x16x16_bf16 v[0:3], v[100:101], v[146:147], v[0:3]
    v_mfma_f32_16x16x16_bf16 v[4:7], v[102:103], v[146:147], v[4:7]
    v_mfma_f32_16x16x16_bf16 v[8:11], v[104:105], v[146:147], v[8:11]
    v_mfma_f32_16x16x16_bf16 v[12:15], v[106:107], v[146:147], v[12:15]
    s_waitcnt vmcnt(16)
    v_cvt_f32_i32 v240, v240
    v_cvt_f32_i32 v241, v241
    v_cvt_f32_i32 v242, v242
    v_cvt_f32_i32 v243, v243
    v_cvt_f32_i32 v244, v244
    v_cvt_f32_i32 v245, v245
    v_cvt_f32_i32 v246, v246
    v_cvt_f32_i32 v247, v247
    v_cvt_f32_i32 v248, v248
    v_cvt_f32_i32 v249, v249
    v_cvt_f32_i32 v250, v250
    v_cvt_f32_i32 v251, v251
    v_cvt_f32_i32 v252, v252
    v_cvt_f32_i32 v253, v253
    v_cvt_f32_i32 v254, v254
    v_cvt_f32_i32 v255, v255
    v_cvt_pk_bf16_f32 v108, v240, v244
    v_cvt_pk_bf16_f32 v109, v248, v252
    v_cvt_pk_bf16_f32 v110, v241, v245
    v_cvt_pk_bf16_f32 v111, v249, v253
    v_cvt_pk_bf16_f32 v112, v242, v246
    v_cvt_pk_bf16_f32 v113, v250, v254
    v_cvt_pk_bf16_f32 v114, v243, v247
    v_cvt_pk_bf16_f32 v115, v251, v255
    s_add_u32 s5, s4, 0x810000
    s_waitcnt vmcnt(1)
    buffer_load_dwordx4 v[224:227], v130, s[40:43], s5 offen offset:0 nt
    buffer_load_dwordx4 v[228:231], v130, s[40:43], s5 offen offset:512 nt
    buffer_load_dwordx4 v[232:235], v130, s[40:43], s5 offen offset:1024 nt
    buffer_load_dwordx4 v[236:239], v130, s[40:43], s5 offen offset:1536 nt
    buffer_load_dwordx4 v[240:243], v130, s[40:43], s5 offen offset:256 nt
    buffer_load_dwordx4 v[244:247], v130, s[40:43], s5 offen offset:768 nt
    buffer_load_dwordx4 v[248:251], v130, s[40:43], s5 offen offset:1280 nt
    buffer_load_dwordx4 v[252:255], v130, s[40:43], s5 offen offset:1792 nt
    v_mfma_f32_16x16x16_bf16 v[16:19], v[108:109], v[146:147], v[16:19]
    v_mfma_f32_16x16x16_bf16 v[20:23], v[110:111], v[146:147], v[20:23]
    v_mfma_f32_16x16x16_bf16 v[24:27], v[112:113], v[146:147], v[24:27]
    v_mfma_f32_16x16x16_bf16 v[28:31], v[114:115], v[146:147], v[28:31]
    v_fma_f32 v68, v68, s13, -v123
    v_fma_f32 v69, v69, s13, -v123
    v_fma_f32 v70, v70, s13, -v123
    v_fma_f32 v71, v71, s13, -v123
    v_exp_f32 v68, v68
    v_exp_f32 v69, v69
    v_exp_f32 v70, v70
    v_exp_f32 v71, v71
    s_waitcnt lgkmcnt(0)
    v_lshlrev_b32 v124, 16, v152
    v_and_b32 v125, s14, v152
    v_lshlrev_b32 v126, 16, v153
    v_and_b32 v127, s14, v153
    ds_read_b64 v[148:149], v135 offset:23808
    ds_read_b64 v[150:151], v135 offset:25856
    v_add_f32 v156, v68, v69
    v_add_f32 v157, v70, v71
    v_mul_f32 v68, v68, v124
    v_mul_f32 v69, v69, v125
    v_mul_f32 v70, v70, v126
    v_mul_f32 v71, v71, v127
    v_add_f32 v156, v156, v157
    v_and_b32 v124, v133, v68
    v_and_b32 v125, v133, v69
    v_and_b32 v126, v133, v70
    v_and_b32 v127, v133, v71
    v_add_f32 v158, v158, v156
    v_sub_f32 v68, v68, v124
    v_sub_f32 v69, v69, v125
    v_sub_f32 v70, v70, v126
    v_sub_f32 v71, v71, v127
    v_perm_b32 v146, v69, v68, s12
    v_perm_b32 v147, v71, v70, s12
    s_nop 1
    v_mfma_f32_16x16x16_bf16 v[96:99], v[154:155], v[146:147], v[96:99]
    s_waitcnt vmcnt(20)
    v_cvt_f32_i32 v160, v160
    v_cvt_f32_i32 v161, v161
    v_cvt_f32_i32 v162, v162
    v_cvt_f32_i32 v163, v163
    v_cvt_f32_i32 v164, v164
    v_cvt_f32_i32 v165, v165
    v_cvt_f32_i32 v166, v166
    v_cvt_f32_i32 v167, v167
    v_cvt_f32_i32 v168, v168
    v_cvt_f32_i32 v169, v169
    v_cvt_f32_i32 v170, v170
    v_cvt_f32_i32 v171, v171
    v_cvt_f32_i32 v172, v172
    v_cvt_f32_i32 v173, v173
    v_cvt_f32_i32 v174, v174
    v_cvt_f32_i32 v175, v175
    v_cvt_pk_bf16_f32 v100, v160, v164
    v_cvt_pk_bf16_f32 v101, v168, v172
    v_cvt_pk_bf16_f32 v102, v161, v165
    v_cvt_pk_bf16_f32 v103, v169, v173
    v_cvt_pk_bf16_f32 v104, v162, v166
    v_cvt_pk_bf16_f32 v105, v170, v174
    v_cvt_pk_bf16_f32 v106, v163, v167
    v_cvt_pk_bf16_f32 v107, v171, v175
    v_mfma_f32_16x16x16_bf16 v[0:3], v[100:101], v[144:145], v[0:3]
    v_mfma_f32_16x16x16_bf16 v[4:7], v[102:103], v[144:145], v[4:7]
    v_mfma_f32_16x16x16_bf16 v[8:11], v[104:105], v[144:145], v[8:11]
    v_mfma_f32_16x16x16_bf16 v[12:15], v[106:107], v[144:145], v[12:15]
    s_waitcnt vmcnt(16)
    v_cvt_f32_i32 v176, v176
    v_cvt_f32_i32 v177, v177
    v_cvt_f32_i32 v178, v178
    v_cvt_f32_i32 v179, v179
    v_cvt_f32_i32 v180, v180
    v_cvt_f32_i32 v181, v181
    v_cvt_f32_i32 v182, v182
    v_cvt_f32_i32 v183, v183
    v_cvt_f32_i32 v184, v184
    v_cvt_f32_i32 v185, v185
    v_cvt_f32_i32 v186, v186
    v_cvt_f32_i32 v187, v187
    v_cvt_f32_i32 v188, v188
    v_cvt_f32_i32 v189, v189
    v_cvt_f32_i32 v190, v190
    v_cvt_f32_i32 v191, v191
    v_cvt_pk_bf16_f32 v108, v176, v180
    v_cvt_pk_bf16_f32 v109, v184, v188
    v_cvt_pk_bf16_f32 v110, v177, v181
    v_cvt_pk_bf16_f32 v111, v185, v189
    v_cvt_pk_bf16_f32 v112, v178, v182
    v_cvt_pk_bf16_f32 v113, v186, v190
    v_cvt_pk_bf16_f32 v114, v179, v183
    v_cvt_pk_bf16_f32 v115, v187, v191
    s_add_u32 s6, s4, 0x818000
    s_waitcnt vmcnt(1)
    buffer_load_dwordx4 v[160:163], v130, s[40:43], s6 offen offset:0 nt
    buffer_load_dwordx4 v[164:167], v130, s[40:43], s6 offen offset:512 nt
    buffer_load_dwordx4 v[168:171], v130, s[40:43], s6 offen offset:1024 nt
    buffer_load_dwordx4 v[172:175], v130, s[40:43], s6 offen offset:1536 nt
    buffer_load_dwordx4 v[176:179], v130, s[40:43], s6 offen offset:256 nt
    buffer_load_dwordx4 v[180:183], v130, s[40:43], s6 offen offset:768 nt
    buffer_load_dwordx4 v[184:187], v130, s[40:43], s6 offen offset:1280 nt
    buffer_load_dwordx4 v[188:191], v130, s[40:43], s6 offen offset:1792 nt
    v_mfma_f32_16x16x16_bf16 v[16:19], v[108:109], v[144:145], v[16:19]
    v_mfma_f32_16x16x16_bf16 v[20:23], v[110:111], v[144:145], v[20:23]
    v_mfma_f32_16x16x16_bf16 v[24:27], v[112:113], v[144:145], v[24:27]
    v_mfma_f32_16x16x16_bf16 v[28:31], v[114:115], v[144:145], v[28:31]
    v_fma_f32 v72, v72, s13, -v123
    v_fma_f32 v73, v73, s13, -v123
    v_fma_f32 v74, v74, s13, -v123
    v_fma_f32 v75, v75, s13, -v123
    v_exp_f32 v72, v72
    v_exp_f32 v73, v73
    v_exp_f32 v74, v74
    v_exp_f32 v75, v75
    s_waitcnt lgkmcnt(0)
    v_lshlrev_b32 v124, 16, v148
    v_and_b32 v125, s14, v148
    v_lshlrev_b32 v126, 16, v149
    v_and_b32 v127, s14, v149
    ds_read_b64 v[152:153], v135 offset:23936
    ds_read_b64 v[154:155], v135 offset:25984
    v_add_f32 v156, v72, v73
    v_add_f32 v157, v74, v75
    v_mul_f32 v72, v72, v124
    v_mul_f32 v73, v73, v125
    v_mul_f32 v74, v74, v126
    v_mul_f32 v75, v75, v127
    v_add_f32 v156, v156, v157
    v_and_b32 v124, v133, v72
    v_and_b32 v125, v133, v73
    v_and_b32 v126, v133, v74
    v_and_b32 v127, v133, v75
    v_add_f32 v158, v158, v156
    v_sub_f32 v72, v72, v124
    v_sub_f32 v73, v73, v125
    v_sub_f32 v74, v74, v126
    v_sub_f32 v75, v75, v127
    v_perm_b32 v144, v73, v72, s12
    v_perm_b32 v145, v75, v74, s12
    s_nop 1
    v_mfma_f32_16x16x16_bf16 v[96:99], v[150:151], v[144:145], v[96:99]
    s_waitcnt vmcnt(20)
    v_cvt_f32_i32 v192, v192
    v_cvt_f32_i32 v193, v193
    v_cvt_f32_i32 v194, v194
    v_cvt_f32_i32 v195, v195
    v_cvt_f32_i32 v196, v196
    v_cvt_f32_i32 v197, v197
    v_cvt_f32_i32 v198, v198
    v_cvt_f32_i32 v199, v199
    v_cvt_f32_i32 v200, v200
    v_cvt_f32_i32 v201, v201
    v_cvt_f32_i32 v202, v202
    v_cvt_f32_i32 v203, v203
    v_cvt_f32_i32 v204, v204
    v_cvt_f32_i32 v205, v205
    v_cvt_f32_i32 v206, v206
    v_cvt_f32_i32 v207, v207
    v_cvt_pk_bf16_f32 v100, v192, v196
    v_cvt_pk_bf16_f32 v101, v200, v204
    v_cvt_pk_bf16_f32 v102, v193, v197
    v_cvt_pk_bf16_f32 v103, v201, v205
    v_cvt_pk_bf16_f32 v104, v194, v198
    v_cvt_pk_bf16_f32 v105, v202, v206
    v_cvt_pk_bf16_f32 v106, v195, v199
    v_cvt_pk_bf16_f32 v107, v203, v207
    v_mfma_f32_16x16x16_bf16 v[0:3], v[100:101], v[146:147], v[0:3]
    v_mfma_f32_16x16x16_bf16 v[4:7], v[102:103], v[146:147], v[4:7]
    v_mfma_f32_16x16x16_bf16 v[8:11], v[104:105], v[146:147], v[8:11]
    v_mfma_f32_16x16x16_bf16 v[12:15], v[106:107], v[146:147], v[12:15]
    s_waitcnt vmcnt(16)
    v_cvt_f32_i32 v208, v208
    v_cvt_f32_i32 v209, v209
    v_cvt_f32_i32 v210, v210
    v_cvt_f32_i32 v211, v211
    v_cvt_f32_i32 v212, v212
    v_cvt_f32_i32 v213, v213
    v_cvt_f32_i32 v214, v214
    v_cvt_f32_i32 v215, v215
    v_cvt_f32_i32 v216, v216
    v_cvt_f32_i32 v217, v217
    v_cvt_f32_i32 v218, v218
    v_cvt_f32_i32 v219, v219
    v_cvt_f32_i32 v220, v220
    v_cvt_f32_i32 v221, v221
    v_cvt_f32_i32 v222, v222
    v_cvt_f32_i32 v223, v223
    v_cvt_pk_bf16_f32 v108, v208, v212
    v_cvt_pk_bf16_f32 v109, v216, v220
    v_cvt_pk_bf16_f32 v110, v209, v213
    v_cvt_pk_bf16_f32 v111, v217, v221
    v_cvt_pk_bf16_f32 v112, v210, v214
    v_cvt_pk_bf16_f32 v113, v218, v222
    v_cvt_pk_bf16_f32 v114, v211, v215
    v_cvt_pk_bf16_f32 v115, v219, v223
    s_add_u32 s5, s4, 0xc00000
    s_waitcnt vmcnt(1)
    buffer_load_dwordx4 v[192:195], v130, s[40:43], s5 offen offset:0 nt
    buffer_load_dwordx4 v[196:199], v130, s[40:43], s5 offen offset:512 nt
    buffer_load_dwordx4 v[200:203], v130, s[40:43], s5 offen offset:1024 nt
    buffer_load_dwordx4 v[204:207], v130, s[40:43], s5 offen offset:1536 nt
    buffer_load_dwordx4 v[208:211], v130, s[40:43], s5 offen offset:256 nt
    buffer_load_dwordx4 v[212:215], v130, s[40:43], s5 offen offset:768 nt
    buffer_load_dwordx4 v[216:219], v130, s[40:43], s5 offen offset:1280 nt
    buffer_load_dwordx4 v[220:223], v130, s[40:43], s5 offen offset:1792 nt
    v_mfma_f32_16x16x16_bf16 v[16:19], v[108:109], v[146:147], v[16:19]
    v_mfma_f32_16x16x16_bf16 v[20:23], v[110:111], v[146:147], v[20:23]
    v_mfma_f32_16x16x16_bf16 v[24:27], v[112:113], v[146:147], v[24:27]
    v_mfma_f32_16x16x16_bf16 v[28:31], v[114:115], v[146:147], v[28:31]
    v_fma_f32 v76, v76, s13, -v123
    v_fma_f32 v77, v77, s13, -v123
    v_fma_f32 v78, v78, s13, -v123
    v_fma_f32 v79, v79, s13, -v123
    v_exp_f32 v76, v76
    v_exp_f32 v77, v77
    v_exp_f32 v78, v78
    v_exp_f32 v79, v79
    s_waitcnt lgkmcnt(0)
    v_lshlrev_b32 v124, 16, v152
    v_and_b32 v125, s14, v152
    v_lshlrev_b32 v126, 16, v153
    v_and_b32 v127, s14, v153
    ds_read_b64 v[148:149], v135 offset:24064
    ds_read_b64 v[150:151], v135 offset:26112
    v_add_f32 v156, v76, v77
    v_add_f32 v157, v78, v79
    v_mul_f32 v76, v76, v124
    v_mul_f32 v77, v77, v125
    v_mul_f32 v78, v78, v126
    v_mul_f32 v79, v79, v127
    v_add_f32 v156, v156, v157
    v_and_b32 v124, v133, v76
    v_and_b32 v125, v133, v77
    v_and_b32 v126, v133, v78
    v_and_b32 v127, v133, v79
    v_add_f32 v158, v158, v156
    v_sub_f32 v76, v76, v124
    v_sub_f32 v77, v77, v125
    v_sub_f32 v78, v78, v126
    v_sub_f32 v79, v79, v127
    v_perm_b32 v146, v77, v76, s12
    v_perm_b32 v147, v79, v78, s12
    s_nop 1
    v_mfma_f32_16x16x16_bf16 v[96:99], v[154:155], v[146:147], v[96:99]
    s_waitcnt vmcnt(20)
    v_cvt_f32_i32 v224, v224
    v_cvt_f32_i32 v225, v225
    v_cvt_f32_i32 v226, v226
    v_cvt_f32_i32 v227, v227
    v_cvt_f32_i32 v228, v228
    v_cvt_f32_i32 v229, v229
    v_cvt_f32_i32 v230, v230
    v_cvt_f32_i32 v231, v231
    v_cvt_f32_i32 v232, v232
    v_cvt_f32_i32 v233, v233
    v_cvt_f32_i32 v234, v234
    v_cvt_f32_i32 v235, v235
    v_cvt_f32_i32 v236, v236
    v_cvt_f32_i32 v237, v237
    v_cvt_f32_i32 v238, v238
    v_cvt_f32_i32 v239, v239
    v_cvt_pk_bf16_f32 v100, v224, v228
    v_cvt_pk_bf16_f32 v101, v232, v236
    v_cvt_pk_bf16_f32 v102, v225, v229
    v_cvt_pk_bf16_f32 v103, v233, v237
    v_cvt_pk_bf16_f32 v104, v226, v230
    v_cvt_pk_bf16_f32 v105, v234, v238
    v_cvt_pk_bf16_f32 v106, v227, v231
    v_cvt_pk_bf16_f32 v107, v235, v239
    v_mfma_f32_16x16x16_bf16 v[0:3], v[100:101], v[144:145], v[0:3]
    v_mfma_f32_16x16x16_bf16 v[4:7], v[102:103], v[144:145], v[4:7]
    v_mfma_f32_16x16x16_bf16 v[8:11], v[104:105], v[144:145], v[8:11]
    v_mfma_f32_16x16x16_bf16 v[12:15], v[106:107], v[144:145], v[12:15]
    s_waitcnt vmcnt(16)
    v_cvt_f32_i32 v240, v240
    v_cvt_f32_i32 v241, v241
    v_cvt_f32_i32 v242, v242
    v_cvt_f32_i32 v243, v243
    v_cvt_f32_i32 v244, v244
    v_cvt_f32_i32 v245, v245
    v_cvt_f32_i32 v246, v246
    v_cvt_f32_i32 v247, v247
    v_cvt_f32_i32 v248, v248
    v_cvt_f32_i32 v249, v249
    v_cvt_f32_i32 v250, v250
    v_cvt_f32_i32 v251, v251
    v_cvt_f32_i32 v252, v252
    v_cvt_f32_i32 v253, v253
    v_cvt_f32_i32 v254, v254
    v_cvt_f32_i32 v255, v255
    v_cvt_pk_bf16_f32 v108, v240, v244
    v_cvt_pk_bf16_f32 v109, v248, v252
    v_cvt_pk_bf16_f32 v110, v241, v245
    v_cvt_pk_bf16_f32 v111, v249, v253
    v_cvt_pk_bf16_f32 v112, v242, v246
    v_cvt_pk_bf16_f32 v113, v250, v254
    v_cvt_pk_bf16_f32 v114, v243, v247
    v_cvt_pk_bf16_f32 v115, v251, v255
    s_add_u32 s6, s4, 0xc08000
    s_waitcnt vmcnt(1)
    buffer_load_dwordx4 v[224:227], v130, s[40:43], s6 offen offset:0 nt
    buffer_load_dwordx4 v[228:231], v130, s[40:43], s6 offen offset:512 nt
    buffer_load_dwordx4 v[232:235], v130, s[40:43], s6 offen offset:1024 nt
    buffer_load_dwordx4 v[236:239], v130, s[40:43], s6 offen offset:1536 nt
    buffer_load_dwordx4 v[240:243], v130, s[40:43], s6 offen offset:256 nt
    buffer_load_dwordx4 v[244:247], v130, s[40:43], s6 offen offset:768 nt
    buffer_load_dwordx4 v[248:251], v130, s[40:43], s6 offen offset:1280 nt
    buffer_load_dwordx4 v[252:255], v130, s[40:43], s6 offen offset:1792 nt
    v_mfma_f32_16x16x16_bf16 v[16:19], v[108:109], v[144:145], v[16:19]
    v_mfma_f32_16x16x16_bf16 v[20:23], v[110:111], v[144:145], v[20:23]
    v_mfma_f32_16x16x16_bf16 v[24:27], v[112:113], v[144:145], v[24:27]
    v_mfma_f32_16x16x16_bf16 v[28:31], v[114:115], v[144:145], v[28:31]
    v_fma_f32 v80, v80, s13, -v123
    v_fma_f32 v81, v81, s13, -v123
    v_fma_f32 v82, v82, s13, -v123
    v_fma_f32 v83, v83, s13, -v123
    v_exp_f32 v80, v80
    v_exp_f32 v81, v81
    v_exp_f32 v82, v82
    v_exp_f32 v83, v83
    s_waitcnt lgkmcnt(0)
    v_lshlrev_b32 v124, 16, v148
    v_and_b32 v125, s14, v148
    v_lshlrev_b32 v126, 16, v149
    v_and_b32 v127, s14, v149
    ds_read_b64 v[152:153], v135 offset:24192
    ds_read_b64 v[154:155], v135 offset:26240
    v_add_f32 v156, v80, v81
    v_add_f32 v157, v82, v83
    v_mul_f32 v80, v80, v124
    v_mul_f32 v81, v81, v125
    v_mul_f32 v82, v82, v126
    v_mul_f32 v83, v83, v127
    v_add_f32 v156, v156, v157
    v_and_b32 v124, v133, v80
    v_and_b32 v125, v133, v81
    v_and_b32 v126, v133, v82
    v_and_b32 v127, v133, v83
    v_add_f32 v158, v158, v156
    v_sub_f32 v80, v80, v124
    v_sub_f32 v81, v81, v125
    v_sub_f32 v82, v82, v126
    v_sub_f32 v83, v83, v127
    v_perm_b32 v144, v81, v80, s12
    v_perm_b32 v145, v83, v82, s12
    s_nop 1
    v_mfma_f32_16x16x16_bf16 v[96:99], v[150:151], v[144:145], v[96:99]
    s_waitcnt vmcnt(20)
    v_cvt_f32_i32 v160, v160
    v_cvt_f32_i32 v161, v161
    v_cvt_f32_i32 v162, v162
    v_cvt_f32_i32 v163, v163
    v_cvt_f32_i32 v164, v164
    v_cvt_f32_i32 v165, v165
    v_cvt_f32_i32 v166, v166
    v_cvt_f32_i32 v167, v167
    v_cvt_f32_i32 v168, v168
    v_cvt_f32_i32 v169, v169
    v_cvt_f32_i32 v170, v170
    v_cvt_f32_i32 v171, v171
    v_cvt_f32_i32 v172, v172
    v_cvt_f32_i32 v173, v173
    v_cvt_f32_i32 v174, v174
    v_cvt_f32_i32 v175, v175
    v_cvt_pk_bf16_f32 v100, v160, v164
    v_cvt_pk_bf16_f32 v101, v168, v172
    v_cvt_pk_bf16_f32 v102, v161, v165
    v_cvt_pk_bf16_f32 v103, v169, v173
    v_cvt_pk_bf16_f32 v104, v162, v166
    v_cvt_pk_bf16_f32 v105, v170, v174
    v_cvt_pk_bf16_f32 v106, v163, v167
    v_cvt_pk_bf16_f32 v107, v171, v175
    v_mfma_f32_16x16x16_bf16 v[0:3], v[100:101], v[146:147], v[0:3]
    v_mfma_f32_16x16x16_bf16 v[4:7], v[102:103], v[146:147], v[4:7]
    v_mfma_f32_16x16x16_bf16 v[8:11], v[104:105], v[146:147], v[8:11]
    v_mfma_f32_16x16x16_bf16 v[12:15], v[106:107], v[146:147], v[12:15]
    s_waitcnt vmcnt(16)
    v_cvt_f32_i32 v176, v176
    v_cvt_f32_i32 v177, v177
    v_cvt_f32_i32 v178, v178
    v_cvt_f32_i32 v179, v179
    v_cvt_f32_i32 v180, v180
    v_cvt_f32_i32 v181, v181
    v_cvt_f32_i32 v182, v182
    v_cvt_f32_i32 v183, v183
    v_cvt_f32_i32 v184, v184
    v_cvt_f32_i32 v185, v185
    v_cvt_f32_i32 v186, v186
    v_cvt_f32_i32 v187, v187
    v_cvt_f32_i32 v188, v188
    v_cvt_f32_i32 v189, v189
    v_cvt_f32_i32 v190, v190
    v_cvt_f32_i32 v191, v191
    v_cvt_pk_bf16_f32 v108, v176, v180
    v_cvt_pk_bf16_f32 v109, v184, v188
    v_cvt_pk_bf16_f32 v110, v177, v181
    v_cvt_pk_bf16_f32 v111, v185, v189
    v_cvt_pk_bf16_f32 v112, v178, v182
    v_cvt_pk_bf16_f32 v113, v186, v190
    v_cvt_pk_bf16_f32 v114, v179, v183
    v_cvt_pk_bf16_f32 v115, v187, v191
    s_add_u32 s5, s4, 0xc10000
    s_waitcnt vmcnt(1)
    buffer_load_dwordx4 v[160:163], v130, s[40:43], s5 offen offset:0 nt
    buffer_load_dwordx4 v[164:167], v130, s[40:43], s5 offen offset:512 nt
    buffer_load_dwordx4 v[168:171], v130, s[40:43], s5 offen offset:1024 nt
    buffer_load_dwordx4 v[172:175], v130, s[40:43], s5 offen offset:1536 nt
    buffer_load_dwordx4 v[176:179], v130, s[40:43], s5 offen offset:256 nt
    buffer_load_dwordx4 v[180:183], v130, s[40:43], s5 offen offset:768 nt
    buffer_load_dwordx4 v[184:187], v130, s[40:43], s5 offen offset:1280 nt
    buffer_load_dwordx4 v[188:191], v130, s[40:43], s5 offen offset:1792 nt
    v_mfma_f32_16x16x16_bf16 v[16:19], v[108:109], v[146:147], v[16:19]
    v_mfma_f32_16x16x16_bf16 v[20:23], v[110:111], v[146:147], v[20:23]
    v_mfma_f32_16x16x16_bf16 v[24:27], v[112:113], v[146:147], v[24:27]
    v_mfma_f32_16x16x16_bf16 v[28:31], v[114:115], v[146:147], v[28:31]
    v_fma_f32 v84, v84, s13, -v123
    v_fma_f32 v85, v85, s13, -v123
    v_fma_f32 v86, v86, s13, -v123
    v_fma_f32 v87, v87, s13, -v123
    v_exp_f32 v84, v84
    v_exp_f32 v85, v85
    v_exp_f32 v86, v86
    v_exp_f32 v87, v87
    s_waitcnt lgkmcnt(0)
    v_lshlrev_b32 v124, 16, v152
    v_and_b32 v125, s14, v152
    v_lshlrev_b32 v126, 16, v153
    v_and_b32 v127, s14, v153
    ds_read_b64 v[148:149], v135 offset:24320
    ds_read_b64 v[150:151], v135 offset:26368
    v_add_f32 v156, v84, v85
    v_add_f32 v157, v86, v87
    v_mul_f32 v84, v84, v124
    v_mul_f32 v85, v85, v125
    v_mul_f32 v86, v86, v126
    v_mul_f32 v87, v87, v127
    v_add_f32 v156, v156, v157
    v_and_b32 v124, v133, v84
    v_and_b32 v125, v133, v85
    v_and_b32 v126, v133, v86
    v_and_b32 v127, v133, v87
    v_add_f32 v158, v158, v156
    v_sub_f32 v84, v84, v124
    v_sub_f32 v85, v85, v125
    v_sub_f32 v86, v86, v126
    v_sub_f32 v87, v87, v127
    v_perm_b32 v146, v85, v84, s12
    v_perm_b32 v147, v87, v86, s12
    s_nop 1
    v_mfma_f32_16x16x16_bf16 v[96:99], v[154:155], v[146:147], v[96:99]
    s_waitcnt vmcnt(20)
    v_cvt_f32_i32 v192, v192
    v_cvt_f32_i32 v193, v193
    v_cvt_f32_i32 v194, v194
    v_cvt_f32_i32 v195, v195
    v_cvt_f32_i32 v196, v196
    v_cvt_f32_i32 v197, v197
    v_cvt_f32_i32 v198, v198
    v_cvt_f32_i32 v199, v199
    v_cvt_f32_i32 v200, v200
    v_cvt_f32_i32 v201, v201
    v_cvt_f32_i32 v202, v202
    v_cvt_f32_i32 v203, v203
    v_cvt_f32_i32 v204, v204
    v_cvt_f32_i32 v205, v205
    v_cvt_f32_i32 v206, v206
    v_cvt_f32_i32 v207, v207
    v_cvt_pk_bf16_f32 v100, v192, v196
    v_cvt_pk_bf16_f32 v101, v200, v204
    v_cvt_pk_bf16_f32 v102, v193, v197
    v_cvt_pk_bf16_f32 v103, v201, v205
    v_cvt_pk_bf16_f32 v104, v194, v198
    v_cvt_pk_bf16_f32 v105, v202, v206
    v_cvt_pk_bf16_f32 v106, v195, v199
    v_cvt_pk_bf16_f32 v107, v203, v207
    v_mfma_f32_16x16x16_bf16 v[0:3], v[100:101], v[144:145], v[0:3]
    v_mfma_f32_16x16x16_bf16 v[4:7], v[102:103], v[144:145], v[4:7]
    v_mfma_f32_16x16x16_bf16 v[8:11], v[104:105], v[144:145], v[8:11]
    v_mfma_f32_16x16x16_bf16 v[12:15], v[106:107], v[144:145], v[12:15]
    s_waitcnt vmcnt(16)
    v_cvt_f32_i32 v208, v208
    v_cvt_f32_i32 v209, v209
    v_cvt_f32_i32 v210, v210
    v_cvt_f32_i32 v211, v211
    v_cvt_f32_i32 v212, v212
    v_cvt_f32_i32 v213, v213
    v_cvt_f32_i32 v214, v214
    v_cvt_f32_i32 v215, v215
    v_cvt_f32_i32 v216, v216
    v_cvt_f32_i32 v217, v217
    v_cvt_f32_i32 v218, v218
    v_cvt_f32_i32 v219, v219
    v_cvt_f32_i32 v220, v220
    v_cvt_f32_i32 v221, v221
    v_cvt_f32_i32 v222, v222
    v_cvt_f32_i32 v223, v223
    v_cvt_pk_bf16_f32 v108, v208, v212
    v_cvt_pk_bf16_f32 v109, v216, v220
    v_cvt_pk_bf16_f32 v110, v209, v213
    v_cvt_pk_bf16_f32 v111, v217, v221
    v_cvt_pk_bf16_f32 v112, v210, v214
    v_cvt_pk_bf16_f32 v113, v218, v222
    v_cvt_pk_bf16_f32 v114, v211, v215
    v_cvt_pk_bf16_f32 v115, v219, v223
    s_add_u32 s6, s4, 0xc18000
    s_waitcnt vmcnt(1)
    buffer_load_dwordx4 v[192:195], v130, s[40:43], s6 offen offset:0 nt
    buffer_load_dwordx4 v[196:199], v130, s[40:43], s6 offen offset:512 nt
    buffer_load_dwordx4 v[200:203], v130, s[40:43], s6 offen offset:1024 nt
    buffer_load_dwordx4 v[204:207], v130, s[40:43], s6 offen offset:1536 nt
    buffer_load_dwordx4 v[208:211], v130, s[40:43], s6 offen offset:256 nt
    buffer_load_dwordx4 v[212:215], v130, s[40:43], s6 offen offset:768 nt
    buffer_load_dwordx4 v[216:219], v130, s[40:43], s6 offen offset:1280 nt
    buffer_load_dwordx4 v[220:223], v130, s[40:43], s6 offen offset:1792 nt
    v_mfma_f32_16x16x16_bf16 v[16:19], v[108:109], v[144:145], v[16:19]
    v_mfma_f32_16x16x16_bf16 v[20:23], v[110:111], v[144:145], v[20:23]
    v_mfma_f32_16x16x16_bf16 v[24:27], v[112:113], v[144:145], v[24:27]
    v_mfma_f32_16x16x16_bf16 v[28:31], v[114:115], v[144:145], v[28:31]
    v_fma_f32 v88, v88, s13, -v123
    v_fma_f32 v89, v89, s13, -v123
    v_fma_f32 v90, v90, s13, -v123
    v_fma_f32 v91, v91, s13, -v123
    v_exp_f32 v88, v88
    v_exp_f32 v89, v89
    v_exp_f32 v90, v90
    v_exp_f32 v91, v91
    s_waitcnt lgkmcnt(0)
    v_lshlrev_b32 v124, 16, v148
    v_and_b32 v125, s14, v148
    v_lshlrev_b32 v126, 16, v149
    v_and_b32 v127, s14, v149
    ds_read_b64 v[152:153], v135 offset:24448
    ds_read_b64 v[154:155], v135 offset:26496
    v_add_f32 v156, v88, v89
    v_add_f32 v157, v90, v91
    v_mul_f32 v88, v88, v124
    v_mul_f32 v89, v89, v125
    v_mul_f32 v90, v90, v126
    v_mul_f32 v91, v91, v127
    v_add_f32 v156, v156, v157
    v_and_b32 v124, v133, v88
    v_and_b32 v125, v133, v89
    v_and_b32 v126, v133, v90
    v_and_b32 v127, v133, v91
    v_add_f32 v158, v158, v156
    v_sub_f32 v88, v88, v124
    v_sub_f32 v89, v89, v125
    v_sub_f32 v90, v90, v126
    v_sub_f32 v91, v91, v127
    v_perm_b32 v144, v89, v88, s12
    v_perm_b32 v145, v91, v90, s12
    s_nop 1
    v_mfma_f32_16x16x16_bf16 v[96:99], v[150:151], v[144:145], v[96:99]
    s_waitcnt vmcnt(20)
    v_cvt_f32_i32 v224, v224
    v_cvt_f32_i32 v225, v225
    v_cvt_f32_i32 v226, v226
    v_cvt_f32_i32 v227, v227
    v_cvt_f32_i32 v228, v228
    v_cvt_f32_i32 v229, v229
    v_cvt_f32_i32 v230, v230
    v_cvt_f32_i32 v231, v231
    v_cvt_f32_i32 v232, v232
    v_cvt_f32_i32 v233, v233
    v_cvt_f32_i32 v234, v234
    v_cvt_f32_i32 v235, v235
    v_cvt_f32_i32 v236, v236
    v_cvt_f32_i32 v237, v237
    v_cvt_f32_i32 v238, v238
    v_cvt_f32_i32 v239, v239
    v_cvt_pk_bf16_f32 v100, v224, v228
    v_cvt_pk_bf16_f32 v101, v232, v236
    v_cvt_pk_bf16_f32 v102, v225, v229
    v_cvt_pk_bf16_f32 v103, v233, v237
    v_cvt_pk_bf16_f32 v104, v226, v230
    v_cvt_pk_bf16_f32 v105, v234, v238
    v_cvt_pk_bf16_f32 v106, v227, v231
    v_cvt_pk_bf16_f32 v107, v235, v239
    v_mfma_f32_16x16x16_bf16 v[0:3], v[100:101], v[146:147], v[0:3]
    v_mfma_f32_16x16x16_bf16 v[4:7], v[102:103], v[146:147], v[4:7]
    v_mfma_f32_16x16x16_bf16 v[8:11], v[104:105], v[146:147], v[8:11]
    v_mfma_f32_16x16x16_bf16 v[12:15], v[106:107], v[146:147], v[12:15]
    s_waitcnt vmcnt(16)
    v_cvt_f32_i32 v240, v240
    v_cvt_f32_i32 v241, v241
    v_cvt_f32_i32 v242, v242
    v_cvt_f32_i32 v243, v243
    v_cvt_f32_i32 v244, v244
    v_cvt_f32_i32 v245, v245
    v_cvt_f32_i32 v246, v246
    v_cvt_f32_i32 v247, v247
    v_cvt_f32_i32 v248, v248
    v_cvt_f32_i32 v249, v249
    v_cvt_f32_i32 v250, v250
    v_cvt_f32_i32 v251, v251
    v_cvt_f32_i32 v252, v252
    v_cvt_f32_i32 v253, v253
    v_cvt_f32_i32 v254, v254
    v_cvt_f32_i32 v255, v255
    v_cvt_pk_bf16_f32 v108, v240, v244
    v_cvt_pk_bf16_f32 v109, v248, v252
    v_cvt_pk_bf16_f32 v110, v241, v245
    v_cvt_pk_bf16_f32 v111, v249, v253
    v_cvt_pk_bf16_f32 v112, v242, v246
    v_cvt_pk_bf16_f32 v113, v250, v254
    v_cvt_pk_bf16_f32 v114, v243, v247
    v_cvt_pk_bf16_f32 v115, v251, v255
    v_mfma_f32_16x16x16_bf16 v[16:19], v[108:109], v[146:147], v[16:19]
    v_mfma_f32_16x16x16_bf16 v[20:23], v[110:111], v[146:147], v[20:23]
    v_mfma_f32_16x16x16_bf16 v[24:27], v[112:113], v[146:147], v[24:27]
    v_mfma_f32_16x16x16_bf16 v[28:31], v[114:115], v[146:147], v[28:31]
    v_fma_f32 v92, v92, s13, -v123
    v_fma_f32 v93, v93, s13, -v123
    v_fma_f32 v94, v94, s13, -v123
    v_fma_f32 v95, v95, s13, -v123
    v_exp_f32 v92, v92
    v_exp_f32 v93, v93
    v_exp_f32 v94, v94
    v_exp_f32 v95, v95
    s_waitcnt lgkmcnt(0)
    v_lshlrev_b32 v124, 16, v152
    v_and_b32 v125, s14, v152
    v_lshlrev_b32 v126, 16, v153
    v_and_b32 v127, s14, v153
    v_add_f32 v156, v92, v93
    v_add_f32 v157, v94, v95
    v_mul_f32 v92, v92, v124
    v_mul_f32 v93, v93, v125
    v_mul_f32 v94, v94, v126
    v_mul_f32 v95, v95, v127
    v_add_f32 v156, v156, v157
    v_and_b32 v124, v133, v92
    v_and_b32 v125, v133, v93
    v_and_b32 v126, v133, v94
    v_and_b32 v127, v133, v95
    v_add_f32 v158, v158, v156
    v_sub_f32 v92, v92, v124
    v_sub_f32 v93, v93, v125
    v_sub_f32 v94, v94, v126
    v_sub_f32 v95, v95, v127
    v_perm_b32 v146, v93, v92, s12
    v_perm_b32 v147, v95, v94, s12
    s_nop 1
    v_mfma_f32_16x16x16_bf16 v[96:99], v[154:155], v[146:147], v[96:99]
    s_waitcnt vmcnt(12)
    v_cvt_f32_i32 v160, v160
    v_cvt_f32_i32 v161, v161
    v_cvt_f32_i32 v162, v162
    v_cvt_f32_i32 v163, v163
    v_cvt_f32_i32 v164, v164
    v_cvt_f32_i32 v165, v165
    v_cvt_f32_i32 v166, v166
    v_cvt_f32_i32 v167, v167
    v_cvt_f32_i32 v168, v168
    v_cvt_f32_i32 v169, v169
    v_cvt_f32_i32 v170, v170
    v_cvt_f32_i32 v171, v171
    v_cvt_f32_i32 v172, v172
    v_cvt_f32_i32 v173, v173
    v_cvt_f32_i32 v174, v174
    v_cvt_f32_i32 v175, v175
    v_cvt_pk_bf16_f32 v100, v160, v164
    v_cvt_pk_bf16_f32 v101, v168, v172
    v_cvt_pk_bf16_f32 v102, v161, v165
    v_cvt_pk_bf16_f32 v103, v169, v173
    v_cvt_pk_bf16_f32 v104, v162, v166
    v_cvt_pk_bf16_f32 v105, v170, v174
    v_cvt_pk_bf16_f32 v106, v163, v167
    v_cvt_pk_bf16_f32 v107, v171, v175
    v_mfma_f32_16x16x16_bf16 v[0:3], v[100:101], v[144:145], v[0:3]
    v_mfma_f32_16x16x16_bf16 v[4:7], v[102:103], v[144:145], v[4:7]
    v_mfma_f32_16x16x16_bf16 v[8:11], v[104:105], v[144:145], v[8:11]
    v_mfma_f32_16x16x16_bf16 v[12:15], v[106:107], v[144:145], v[12:15]
    s_waitcnt vmcnt(8)
    v_cvt_f32_i32 v176, v176
    v_cvt_f32_i32 v177, v177
    v_cvt_f32_i32 v178, v178
    v_cvt_f32_i32 v179, v179
    v_cvt_f32_i32 v180, v180
    v_cvt_f32_i32 v181, v181
    v_cvt_f32_i32 v182, v182
    v_cvt_f32_i32 v183, v183
    v_cvt_f32_i32 v184, v184
    v_cvt_f32_i32 v185, v185
    v_cvt_f32_i32 v186, v186
    v_cvt_f32_i32 v187, v187
    v_cvt_f32_i32 v188, v188
    v_cvt_f32_i32 v189, v189
    v_cvt_f32_i32 v190, v190
    v_cvt_f32_i32 v191, v191
    v_cvt_pk_bf16_f32 v108, v176, v180
    v_cvt_pk_bf16_f32 v109, v184, v188
    v_cvt_pk_bf16_f32 v110, v177, v181
    v_cvt_pk_bf16_f32 v111, v185, v189
    v_cvt_pk_bf16_f32 v112, v178, v182
    v_cvt_pk_bf16_f32 v113, v186, v190
    v_cvt_pk_bf16_f32 v114, v179, v183
    v_cvt_pk_bf16_f32 v115, v187, v191
    v_mfma_f32_16x16x16_bf16 v[16:19], v[108:109], v[144:145], v[16:19]
    v_mfma_f32_16x16x16_bf16 v[20:23], v[110:111], v[144:145], v[20:23]
    v_mfma_f32_16x16x16_bf16 v[24:27], v[112:113], v[144:145], v[24:27]
    v_mfma_f32_16x16x16_bf16 v[28:31], v[114:115], v[144:145], v[28:31]
    v_mov_b32 v156, v158
    v_mov_b32 v157, v156
    s_nop 1
    v_permlane32_swap_b32 v156, v157
    s_nop 1
    v_add_f32 v156, v156, v157
    v_mov_b32 v157, v156
    s_nop 1
    v_permlane16_swap_b32 v156, v157
    s_nop 1
    v_add_f32 v156, v156, v157
    ds_write_b32 v140, v156 offset:28800
    v_sub_f32 v0, v0, v96
    v_sub_f32 v1, v1, v96
    v_sub_f32 v2, v2, v96
    v_sub_f32 v3, v3, v96
    v_sub_f32 v4, v4, v96
    v_sub_f32 v5, v5, v96
    v_sub_f32 v6, v6, v96
    v_sub_f32 v7, v7, v96
    v_sub_f32 v8, v8, v96
    v_sub_f32 v9, v9, v96
    v_sub_f32 v10, v10, v96
    v_sub_f32 v11, v11, v96
    v_sub_f32 v12, v12, v96
    v_sub_f32 v13, v13, v96
    v_sub_f32 v14, v14, v96
    v_sub_f32 v15, v15, v96
    v_sub_f32 v16, v16, v96
    v_sub_f32 v17, v17, v96
    v_sub_f32 v18, v18, v96
    v_sub_f32 v19, v19, v96
    v_sub_f32 v20, v20, v96
    v_sub_f32 v21, v21, v96
    v_sub_f32 v22, v22, v96
    v_sub_f32 v23, v23, v96
    v_sub_f32 v24, v24, v96
    v_sub_f32 v25, v25, v96
    v_sub_f32 v26, v26, v96
    v_sub_f32 v27, v27, v96
    v_sub_f32 v28, v28, v96
    v_sub_f32 v29, v29, v96
    v_sub_f32 v30, v30, v96
    v_sub_f32 v31, v31, v96
    s_waitcnt vmcnt(7)
    v_cvt_f32_i32 v192, v192
    v_cvt_f32_i32 v193, v193
    v_cvt_f32_i32 v194, v194
    v_cvt_f32_i32 v195, v195
    s_waitcnt vmcnt(6)
    v_cvt_f32_i32 v196, v196
    v_cvt_f32_i32 v197, v197
    v_cvt_f32_i32 v198, v198
    v_cvt_f32_i32 v199, v199
    v_cvt_pk_bf16_f32 v100, v192, v196
    v_cvt_pk_bf16_f32 v102, v193, v197
    v_cvt_pk_bf16_f32 v104, v194, v198
    v_cvt_pk_bf16_f32 v106, v195, v199
    s_waitcnt vmcnt(5)
    v_cvt_f32_i32 v200, v200
    v_cvt_f32_i32 v201, v201
    v_cvt_f32_i32 v202, v202
    v_cvt_f32_i32 v203, v203
    s_waitcnt vmcnt(4)
    v_cvt_f32_i32 v204, v204
    v_cvt_f32_i32 v205, v205
    v_cvt_f32_i32 v206, v206
    v_cvt_f32_i32 v207, v207
    v_cvt_pk_bf16_f32 v101, v200, v204
    v_cvt_pk_bf16_f32 v103, v201, v205
    v_cvt_pk_bf16_f32 v105, v202, v206
    v_cvt_pk_bf16_f32 v107, v203, v207
    v_mfma_f32_16x16x16_bf16 v[0:3], v[100:101], v[146:147], v[0:3]
    v_mfma_f32_16x16x16_bf16 v[4:7], v[102:103], v[146:147], v[4:7]
    v_mfma_f32_16x16x16_bf16 v[8:11], v[104:105], v[146:147], v[8:11]
    v_mfma_f32_16x16x16_bf16 v[12:15], v[106:107], v[146:147], v[12:15]
    s_waitcnt vmcnt(3)
    v_cvt_f32_i32 v208, v208
    v_cvt_f32_i32 v209, v209
    v_cvt_f32_i32 v210, v210
    v_cvt_f32_i32 v211, v211
    s_waitcnt vmcnt(2)
    v_cvt_f32_i32 v212, v212
    v_cvt_f32_i32 v213, v213
    v_cvt_f32_i32 v214, v214
    v_cvt_f32_i32 v215, v215
    v_cvt_pk_bf16_f32 v108, v208, v212
    v_cvt_pk_bf16_f32 v110, v209, v213
    v_cvt_pk_bf16_f32 v112, v210, v214
    v_cvt_pk_bf16_f32 v114, v211, v215
    v_add_f32_dpp v32, v0, v0 row_ror:8 row_mask:0xf bank_mask:0x3
    v_add_f32_dpp v36, v1, v1 row_ror:8 row_mask:0xf bank_mask:0x3
    v_add_f32_dpp v40, v2, v2 row_ror:8 row_mask:0xf bank_mask:0x3
    v_add_f32_dpp v44, v3, v3 row_ror:8 row_mask:0xf bank_mask:0x3
    v_add_f32_dpp v33, v4, v4 row_ror:8 row_mask:0xf bank_mask:0x3
    v_add_f32_dpp v37, v5, v5 row_ror:8 row_mask:0xf bank_mask:0x3
    v_add_f32_dpp v41, v6, v6 row_ror:8 row_mask:0xf bank_mask:0x3
    v_add_f32_dpp v45, v7, v7 row_ror:8 row_mask:0xf bank_mask:0x3
    v_add_f32_dpp v34, v8, v8 row_ror:8 row_mask:0xf bank_mask:0x3
    v_add_f32_dpp v38, v9, v9 row_ror:8 row_mask:0xf bank_mask:0x3
    v_add_f32_dpp v42, v10, v10 row_ror:8 row_mask:0xf bank_mask:0x3
    v_add_f32_dpp v46, v11, v11 row_ror:8 row_mask:0xf bank_mask:0x3
    v_add_f32_dpp v35, v12, v12 row_ror:8 row_mask:0xf bank_mask:0x3
    v_add_f32_dpp v39, v13, v13 row_ror:8 row_mask:0xf bank_mask:0x3
    v_add_f32_dpp v43, v14, v14 row_ror:8 row_mask:0xf bank_mask:0x3
    v_add_f32_dpp v47, v15, v15 row_ror:8 row_mask:0xf bank_mask:0x3
    s_waitcnt vmcnt(1)
    v_cvt_f32_i32 v216, v216
    v_cvt_f32_i32 v217, v217
    v_cvt_f32_i32 v218, v218
    v_cvt_f32_i32 v219, v219
    s_waitcnt vmcnt(0)
    v_cvt_f32_i32 v220, v220
    v_cvt_f32_i32 v221, v221
    v_cvt_f32_i32 v222, v222
    v_cvt_f32_i32 v223, v223
    v_cvt_pk_bf16_f32 v109, v216, v220
    v_cvt_pk_bf16_f32 v111, v217, v221
    v_cvt_pk_bf16_f32 v113, v218, v222
    v_cvt_pk_bf16_f32 v115, v219, v223
    v_mfma_f32_16x16x16_bf16 v[16:19], v[108:109], v[146:147], v[16:19]
    v_mfma_f32_16x16x16_bf16 v[20:23], v[110:111], v[146:147], v[20:23]
    v_mfma_f32_16x16x16_bf16 v[24:27], v[112:113], v[146:147], v[24:27]
    v_mfma_f32_16x16x16_bf16 v[28:31], v[114:115], v[146:147], v[28:31]
    s_nop 4
    v_add_f32_dpp v32, v16, v16 row_ror:8 row_mask:0xf bank_mask:0xc
    v_add_f32_dpp v36, v17, v17 row_ror:8 row_mask:0xf bank_mask:0xc
    v_add_f32_dpp v40, v18, v18 row_ror:8 row_mask:0xf bank_mask:0xc
    v_add_f32_dpp v44, v19, v19 row_ror:8 row_mask:0xf bank_mask:0xc
    v_add_f32_dpp v33, v20, v20 row_ror:8 row_mask:0xf bank_mask:0xc
    v_add_f32_dpp v37, v21, v21 row_ror:8 row_mask:0xf bank_mask:0xc
    v_add_f32_dpp v41, v22, v22 row_ror:8 row_mask:0xf bank_mask:0xc
    v_add_f32_dpp v45, v23, v23 row_ror:8 row_mask:0xf bank_mask:0xc
    v_add_f32_dpp v34, v24, v24 row_ror:8 row_mask:0xf bank_mask:0xc
    v_add_f32_dpp v38, v25, v25 row_ror:8 row_mask:0xf bank_mask:0xc
    v_add_f32_dpp v42, v26, v26 row_ror:8 row_mask:0xf bank_mask:0xc
    v_add_f32_dpp v46, v27, v27 row_ror:8 row_mask:0xf bank_mask:0xc
    v_add_f32_dpp v35, v28, v28 row_ror:8 row_mask:0xf bank_mask:0xc
    ds_write_b128 v117, v[32:35] offset:0
    v_add_f32_dpp v39, v29, v29 row_ror:8 row_mask:0xf bank_mask:0xc
    ds_write_b128 v117, v[36:39] offset:16
    v_add_f32_dpp v43, v30, v30 row_ror:8 row_mask:0xf bank_mask:0xc
    ds_write_b128 v117, v[40:43] offset:32
    v_add_f32_dpp v47, v31, v31 row_ror:8 row_mask:0xf bank_mask:0xc
    ds_write_b128 v117, v[44:47] offset:48
    s_waitcnt lgkmcnt(0)
    s_barrier
    ds_read_b128 v[16:19], v121 offset:28672
    ds_read_b128 v[20:23], v121 offset:28800
    ds_read_b64 v[0:1], v118 offset:0
    ds_read_b64 v[2:3], v118 offset:256
    ds_read_b64 v[4:5], v118 offset:4608
    ds_read_b64 v[6:7], v118 offset:4864
    ds_read_b64 v[8:9], v118 offset:9216
    ds_read_b64 v[10:11], v118 offset:9472
    ds_read_b64 v[12:13], v118 offset:13824
    ds_read_b64 v[14:15], v118 offset:14080
    ds_read_b32 v136, v137 offset:28928
    s_waitcnt lgkmcnt(10)
    v_max3_f32 v24, v16, v17, v18
    v_max_f32 v24, v24, v19
    v_sub_f32 v16, v16, v24
    v_sub_f32 v17, v17, v24
    v_sub_f32 v18, v18, v24
    v_sub_f32 v19, v19, v24
    v_exp_f32 v16, v16
    v_exp_f32 v17, v17
    v_exp_f32 v18, v18
    v_exp_f32 v19, v19
    s_waitcnt lgkmcnt(9)
    v_mul_f32 v25, v16, v20
    v_fmac_f32 v25, v17, v21
    v_fmac_f32 v25, v18, v22
    v_fmac_f32 v25, v19, v23
    v_rcp_f32 v26, v25
    v_log_f32 v27, v25
    s_nop 0
    v_mul_f32 v16, v16, v26
    v_mul_f32 v17, v17, v26
    v_mul_f32 v18, v18, v26
    v_mul_f32 v19, v19, v26
    v_add_f32 v34, v24, v27
    v_add_f32 v38, v24, v27
    s_waitcnt lgkmcnt(0)
    v_mul_f32 v32, v16, v0
    v_mul_f32 v33, v16, v1
    v_mul_f32 v36, v16, v2
    v_mul_f32 v37, v16, v3
    v_fmac_f32 v32, v17, v4
    v_fmac_f32 v33, v17, v5
    v_fmac_f32 v36, v17, v6
    v_fmac_f32 v37, v17, v7
    v_fmac_f32 v32, v18, v8
    v_fmac_f32 v33, v18, v9
    v_fmac_f32 v36, v18, v10
    v_fmac_f32 v37, v18, v11
    v_fmac_f32 v32, v19, v12
    v_fmac_f32 v33, v19, v13
    v_fmac_f32 v36, v19, v14
    v_fmac_f32 v37, v19, v15
    v_mov_b32 v35, v136
    v_mov_b32 v39, v136
    s_cmp_lt_u32 s67, 16
    buffer_store_dwordx4 v[32:35], v119, s[52:55], s22 offen sc1
    buffer_store_dwordx4 v[36:39], v119, s[52:55], s22 offen offset:512 sc1
    s_cbranch_scc0 L_fin_done
L_poll:
    buffer_load_dwordx4 v[48:51], v138, s[52:55], s16 offen sc1
    buffer_load_dwordx4 v[52:55], v138, s[52:55], s17 offen sc1
    buffer_load_dwordx4 v[56:59], v138, s[52:55], s18 offen sc1
    buffer_load_dwordx4 v[60:63], v138, s[52:55], s19 offen sc1
    s_sub_u32 s21, s21, 1
    s_cbranch_scc1 L_fin_done
    s_waitcnt vmcnt(3)
    v_xor_b32 v64, v51, v136
    v_xor_b32_dpp v68, v50, v50 quad_perm:[1,0,3,2] row_mask:0xf bank_mask:0xf
    s_waitcnt vmcnt(2)
    v_xor_b32 v65, v55, v136
    v_xor_b32_dpp v69, v54, v54 quad_perm:[1,0,3,2] row_mask:0xf bank_mask:0xf
    s_waitcnt vmcnt(1)
    v_xor_b32 v66, v59, v136
    v_xor_b32_dpp v70, v58, v58 quad_perm:[1,0,3,2] row_mask:0xf bank_mask:0xf
    s_waitcnt vmcnt(0)
    v_xor_b32 v67, v63, v136
    v_xor_b32_dpp v71, v62, v62 quad_perm:[1,0,3,2] row_mask:0xf bank_mask:0xf
    v_or3_b32 v64, v64, v65, v66
    v_or3_b32 v68, v68, v69, v70
    v_or3_b32 v64, v64, v67, v71
    v_or_b32 v64, v64, v68
    v_cmp_ne_u32 vcc, 0, v64
    v_max3_f32 v72, v50, v54, v58
    v_max_f32 v72, v72, v62
    s_cbranch_vccnz L_poll
    s_nop 1
    v_max_f32_dpp v72, v72, v72 row_ror:8 row_mask:0xf bank_mask:0xf
    v_mov_b32 v73, v72
    s_nop 1
    v_permlane16_swap_b32 v72, v73
    s_nop 1
    v_max_f32 v72, v72, v73
    v_mov_b32 v73, v72
    s_nop 1
    v_permlane32_swap_b32 v72, v73
    s_nop 1
    v_max_f32 v72, v72, v73
    v_sub_f32 v50, v50, v72
    v_sub_f32 v54, v54, v72
    v_sub_f32 v58, v58, v72
    v_sub_f32 v62, v62, v72
    v_exp_f32 v50, v50
    v_exp_f32 v54, v54
    v_exp_f32 v58, v58
    v_exp_f32 v62, v62
    v_add_f32 v74, v50, v54
    v_mul_f32 v75, v50, v48
    v_mul_f32 v76, v50, v49
    v_add_f32 v74, v74, v58
    v_fmac_f32 v75, v54, v52
    v_fmac_f32 v76, v54, v53
    v_fmac_f32 v75, v58, v56
    v_fmac_f32 v76, v58, v57
    v_fmac_f32 v75, v62, v60
    v_fmac_f32 v76, v62, v61
    v_add_f32 v74, v74, v62
    s_nop 1
    v_add_f32_dpp v74, v74, v74 row_ror:8 row_mask:0xf bank_mask:0xf
    v_add_f32_dpp v75, v75, v75 row_ror:8 row_mask:0xf bank_mask:0xf
    v_add_f32_dpp v76, v76, v76 row_ror:8 row_mask:0xf bank_mask:0xf
    v_mov_b32 v77, v74
    v_mov_b32 v78, v75
    v_mov_b32 v79, v76
    s_nop 1
    v_permlane16_swap_b32 v74, v77
    v_permlane16_swap_b32 v75, v78
    v_permlane16_swap_b32 v76, v79
    s_nop 1
    v_add_f32 v74, v74, v77
    v_add_f32 v75, v75, v78
    v_add_f32 v76, v76, v79
    v_mov_b32 v77, v74
    v_mov_b32 v78, v75
    v_mov_b32 v79, v76
    s_nop 1
    v_permlane32_swap_b32 v74, v77
    v_permlane32_swap_b32 v75, v78
    v_permlane32_swap_b32 v76, v79
    s_nop 1
    v_add_f32 v74, v74, v77
    v_add_f32 v75, v75, v78
    v_add_f32 v76, v76, v79
    v_rcp_f32 v74, v74
    s_mov_b64 exec, 0xff
    v_mul_f32 v75, v75, v74
    v_mul_f32 v76, v76, v74
    v_cvt_pk_bf16_f32 v75, v75, v76
    buffer_store_dword v75, v139, s[60:63], s20 offen
    s_mov_b64 exec, -1
L_fin_done:
L_main_end:
    s_endpgm
.section .rodata,"a"
.p2align 6
.amdhsa_kernel standalone__kv_cache_quant_int4_int2_kv_with_per_channel_or_per_token_scales__decode_kernel
  .amdhsa_next_free_vgpr 264
  .amdhsa_next_free_sgpr 96
  .amdhsa_accum_offset 256
  .amdhsa_group_segment_fixed_size 0
  .amdhsa_kernarg_size 80
  .amdhsa_user_sgpr_count 2
  .amdhsa_user_sgpr_kernarg_segment_ptr 1
  .amdhsa_system_sgpr_workgroup_id_x 1
.end_amdhsa_kernel
```
